```python
import torch

def _softmax(x, axis=-1):
    return torch.softmax(x, dim=axis)
def _gelu(x):
    return torch.nn.functional.gelu(x, approximate="tanh")
def _silu(x):
    return torch.nn.functional.silu(x)
def _sigmoid(x):
    return torch.sigmoid(x)
def _layernorm(x, axis=-1, eps=1e-5):
    m = x.mean(dim=axis, keepdim=True)
    v = x.var(dim=axis, keepdim=True, unbiased=False)
    return (x - m) / torch.sqrt(v + eps)
def _scatter_add(tgt, idx, src, axis=0):
    return tgt.clone().index_add_(axis, idx, src)
def _segment_sum(src, seg, n):
    out = torch.zeros((n,) + src.shape[1:], dtype=src.dtype)
    return out.index_add_(0, seg, src)
def _pad(x, pw):
    flat = tuple(v for pair in reversed(pw) for v in pair)
    return torch.nn.functional.pad(x, flat)

kernel_name = 'sequential_preLN__sliding_block_cached__mixer_token_mlp__decode'

def setup_inputs():

    _w = (lambda a: (lambda t: t.to(torch.bfloat16) if t.is_floating_point() else t)(torch.as_tensor(a)))
    def _A_setup():
        B, Sq, D = 1, 1, 640
        Hq, Hkv, Sk, Dh = 32, 32, 32768, 192
        assert Hq % Hkv == 0, (Hq, Hkv)
        return {
            "x": _w((lambda *s: torch.randn(*s, dtype=torch.bfloat16) * 0.05)(B, Sq, D)),
            "k_cache": _w((lambda *s: torch.randn(*s, dtype=torch.bfloat16) * 1.6)(B, Hkv, Sk, Dh)),
            "v_cache": _w((lambda *s: torch.randn(*s, dtype=torch.bfloat16) * 0.4)(B, Hkv, Sk, Dh)),
            "wq": _w((lambda *s: torch.randn(*s, dtype=torch.bfloat16) * 1.6)(D, Hq * Dh) * (D ** -0.5)),
            "wo": _w((lambda *s: torch.randn(*s, dtype=torch.bfloat16) * 0.4)(Hq * Dh, D) * ((Hq * Dh) ** -0.5)),
        }
    _A_in = _A_setup()

    def _B_setup():
        B, S, D, F = 1, 1, 640, 1536
        return {
            "x": _w((lambda *s: torch.randn(*s, dtype=torch.bfloat16) * 0.05)(B, S, D)),
            "w1": _w((lambda *s: torch.randn(*s, dtype=torch.bfloat16) * 3.2)(S, F) * (S ** -0.5)),
            "b1": _w((lambda *s: torch.randn(*s, dtype=torch.bfloat16) * 1.6)(F) * 0.02),
            "w2": _w((lambda *s: torch.randn(*s, dtype=torch.bfloat16) * 1.6)(F, S) * (F ** -0.5)),
            "b2": _w((lambda *s: torch.randn(*s, dtype=torch.bfloat16) * 1.6)(S) * 0.02),
        }
    _B_in = _B_setup()

    return {
        "A_x": _A_in["x"],
        "A_k_cache": _A_in["k_cache"],
        "A_v_cache": _A_in["v_cache"],
        "A_wq": _A_in["wq"],
        "A_wo": _A_in["wo"],
        "B_x": _B_in["x"],
        "B_w1": _B_in["w1"],
        "B_b1": _B_in["b1"],
        "B_w2": _B_in["w2"],
        "B_b2": _B_in["b2"],
    }

def reference(A_x, A_k_cache, A_v_cache, A_wq, A_wo, B_x, B_w1, B_b1, B_w2, B_b2):
    def _A_ref(x, k_cache, v_cache, wq, wo):
        B, Sq, D = x.shape
        Hq, Dh = 32, 192
        Hkv, Sk = k_cache.shape[1], k_cache.shape[2]
        W = min(4096, max(256, Sk // 4))
        rep = Hq // Hkv
        q = (lambda x, *d: x.permute(*d))((x @ wq).reshape(B, Sq, Hq, Dh), 0, 2, 1, 3)
        k = (lambda x, n, axis: torch.repeat_interleave(x, n, dim=axis))(k_cache[:, :, Sk - W:, :], rep, axis=1)
        v = (lambda x, n, axis: torch.repeat_interleave(x, n, dim=axis))(v_cache[:, :, Sk - W:, :], rep, axis=1)
        scores = torch.einsum("bhqd,bhkd->bhqk", q, k) * (Dh ** -0.5)
        p = _softmax(scores, axis=-1)
        o = torch.einsum("bhqk,bhkd->bhqd", p, v)
        return (lambda x, *d: x.permute(*d))(o, 0, 2, 1, 3).reshape(B, Sq, Hq * Dh) @ wo

    def _B_ref(x, w1, b1, w2, b2):
        B, S, D = x.shape
        h = _layernorm(x, axis=-1)
        u = torch.einsum("bsd,sf->bdf", h, w1) + b1
        u = _gelu(u)
        y = torch.einsum("bdf,fs->bds", u, w2) + b2
        return (lambda x, *d: x.permute(*d))(y, 0, 2, 1)

    x = A_x
    h = x + _A_ref(_layernorm(x, axis=-1), A_k_cache, A_v_cache, A_wq, A_wo)
    h2 = h + _B_ref(_layernorm(h, axis=-1), B_w1, B_b1, B_w2, B_b2)
    return h2
```

```asm
; @launch grid=(256,1,1) block=(512,1,1) lds=18944
.amdgcn_target "amdgcn-amd-amdhsa--gfx950"
.text
.globl sequential_preLN__sliding_block_cached__mixer_token_mlp__decode_kernel
.p2align 8
.type sequential_preLN__sliding_block_cached__mixer_token_mlp__decode_kernel,@function
sequential_preLN__sliding_block_cached__mixer_token_mlp__decode_kernel:
  s_load_dwordx16 s[16:31], s[0:1], 0
  s_load_dwordx8 s[32:39], s[0:1], 64
  s_load_dwordx2 s[40:41], s[0:1], 96
  s_cmp_ge_u32 s2, 256
  s_cbranch_scc1 L_end
  v_lshrrev_b32 v1, 6, v0
  v_and_b32 v0, 63, v0
  v_readfirstlane_b32 s3, v1
  s_and_b32 s4, s2, 31
  s_lshr_b32 s5, s2, 5
  v_lshrrev_b32 v2, 3, v0
  v_and_b32 v3, 7, v0
  v_mul_u32_u24 v1, 384, v2
  v_lshl_add_u32 v1, v3, 4, v1
  s_lshl_b32 s8, s4, 6
  s_lshl_b32 s8, s8, 3
  s_lshl_b32 s7, s5, 3
  s_add_u32 s8, s8, s7
  s_add_u32 s8, s8, 448
  s_mul_i32 s8, s8, 24576
  s_mul_i32 s70, s2, 11
  s_add_u32 s70, s70, s3
  s_and_b32 s70, s70, 63
  s_cmp_gt_u32 s3, 4
  s_cbranch_scc1 L_qproj
  s_waitcnt lgkmcnt(0)
  s_add_u32 s44, s18, s8
  s_addc_u32 s45, s19, 0
  s_mov_b32 s46, 196608
  s_mov_b32 s47, 0x20000
  s_add_u32 s48, s20, s8
  s_addc_u32 s49, s21, 0
  s_mov_b32 s50, 196608
  s_mov_b32 s51, 0x20000
  s_add_u32 s8, s70, 0
  s_and_b32 s8, s8, 63
  s_mul_i32 s8, s8, 3072
  buffer_load_dwordx4 v[64:67], v1, s[44:47], s8 offen offset:0 nt
  buffer_load_dwordx4 v[68:71], v1, s[44:47], s8 offen offset:128 nt
  buffer_load_dwordx4 v[72:75], v1, s[44:47], s8 offen offset:256 nt
  s_barrier
  s_add_u32 s8, s70, 8
  s_and_b32 s8, s8, 63
  s_mul_i32 s8, s8, 3072
  buffer_load_dwordx4 v[76:79], v1, s[44:47], s8 offen offset:0 nt
  buffer_load_dwordx4 v[80:83], v1, s[44:47], s8 offen offset:128 nt
  buffer_load_dwordx4 v[84:87], v1, s[44:47], s8 offen offset:256 nt
  s_add_u32 s8, s70, 16
  s_and_b32 s8, s8, 63
  s_mul_i32 s8, s8, 3072
  buffer_load_dwordx4 v[88:91], v1, s[44:47], s8 offen offset:0 nt
  buffer_load_dwordx4 v[92:95], v1, s[44:47], s8 offen offset:128 nt
  buffer_load_dwordx4 v[96:99], v1, s[44:47], s8 offen offset:256 nt
  s_add_u32 s8, s70, 24
  s_and_b32 s8, s8, 63
  s_mul_i32 s8, s8, 3072
  buffer_load_dwordx4 v[100:103], v1, s[44:47], s8 offen offset:0 nt
  buffer_load_dwordx4 v[104:107], v1, s[44:47], s8 offen offset:128 nt
  buffer_load_dwordx4 v[108:111], v1, s[44:47], s8 offen offset:256 nt
  s_add_u32 s8, s70, 32
  s_and_b32 s8, s8, 63
  s_mul_i32 s8, s8, 3072
  buffer_load_dwordx4 v[112:115], v1, s[44:47], s8 offen offset:0 nt
  buffer_load_dwordx4 v[116:119], v1, s[44:47], s8 offen offset:128 nt
  buffer_load_dwordx4 v[120:123], v1, s[44:47], s8 offen offset:256 nt
  s_add_u32 s8, s70, 40
  s_and_b32 s8, s8, 63
  s_mul_i32 s8, s8, 3072
  buffer_load_dwordx4 v[124:127], v1, s[44:47], s8 offen offset:0 nt
  buffer_load_dwordx4 v[128:131], v1, s[44:47], s8 offen offset:128 nt
  buffer_load_dwordx4 v[132:135], v1, s[44:47], s8 offen offset:256 nt
  s_add_u32 s8, s70, 48
  s_and_b32 s8, s8, 63
  s_mul_i32 s8, s8, 3072
  buffer_load_dwordx4 v[136:139], v1, s[44:47], s8 offen offset:0 nt
  buffer_load_dwordx4 v[140:143], v1, s[44:47], s8 offen offset:128 nt
  buffer_load_dwordx4 v[144:147], v1, s[44:47], s8 offen offset:256 nt
  s_add_u32 s8, s70, 56
  s_and_b32 s8, s8, 63
  s_mul_i32 s8, s8, 3072
  buffer_load_dwordx4 v[148:151], v1, s[44:47], s8 offen offset:0 nt
  buffer_load_dwordx4 v[152:155], v1, s[44:47], s8 offen offset:128 nt
  buffer_load_dwordx4 v[156:159], v1, s[44:47], s8 offen offset:256 nt
  s_add_u32 s8, s70, 0
  s_and_b32 s8, s8, 63
  s_mul_i32 s8, s8, 3072
  buffer_load_dwordx4 v[160:163], v1, s[48:51], s8 offen offset:0 nt
  buffer_load_dwordx4 v[164:167], v1, s[48:51], s8 offen offset:128 nt
  buffer_load_dwordx4 v[168:171], v1, s[48:51], s8 offen offset:256 nt
  s_add_u32 s8, s70, 8
  s_and_b32 s8, s8, 63
  s_mul_i32 s8, s8, 3072
  buffer_load_dwordx4 v[172:175], v1, s[48:51], s8 offen offset:0 nt
  buffer_load_dwordx4 v[176:179], v1, s[48:51], s8 offen offset:128 nt
  buffer_load_dwordx4 v[180:183], v1, s[48:51], s8 offen offset:256 nt
  s_add_u32 s8, s70, 16
  s_and_b32 s8, s8, 63
  s_mul_i32 s8, s8, 3072
  buffer_load_dwordx4 v[184:187], v1, s[48:51], s8 offen offset:0 nt
  buffer_load_dwordx4 v[188:191], v1, s[48:51], s8 offen offset:128 nt
  buffer_load_dwordx4 v[192:195], v1, s[48:51], s8 offen offset:256 nt
  s_lshl_b32 s6, s4, 3
  s_add_u32 s6, s6, s5
  s_mov_b32 s72, 0x07060500
  s_mov_b32 s73, 0x07060501
  s_mov_b32 s74, 0x07060502
  s_mov_b32 s75, 0x07060503
  s_mov_b32 s76, 0x0c0c0400
  s_mov_b32 s77, 0x04000c0c
  s_mov_b32 s78, 1048576
  s_lshr_b32 s42, s5, 1
  s_and_b32 s43, s5, 1
  s_cmp_lt_u32 s2, 160
  s_cselect_b32 s39, 1, 0
  s_min_u32 s13, s2, 159
  s_mov_b32 s38, s13
  s_cmp_ge_u32 s13, 80
  s_cselect_b32 s14, 1, 0
  s_mul_i32 s12, s14, 80
  s_sub_u32 s12, s13, s12
  s_mul_i32 s68, s14, 320
  s_lshr_b32 s69, s12, 4
  s_lshl_b32 s69, s69, 6
  s_add_u32 s68, s68, s69
  s_and_b32 s69, s12, 3
  s_lshl_b32 s69, s69, 4
  s_add_u32 s68, s68, s69
  s_bfe_u32 s69, s12, 0x20002
  s_lshl_b32 s69, s69, 1
  s_add_u32 s68, s68, s69
  s_lshl_b32 s68, s68, 1
  s_mov_b32 s52, s40
  s_mov_b32 s53, s41
  s_mov_b32 s54, 1081344
  s_mov_b32 s55, 0x20000
  s_mov_b32 s56, s16
  s_mov_b32 s57, s17
  s_mov_b32 s58, 1280
  s_mov_b32 s59, 0x20000
  s_cmp_eq_u32 s3, 0
  s_cbranch_scc1 L_w0

  s_branch L_bar0
L_w0:
  buffer_load_dword v4, off, s[52:55], 0 sc1
  s_add_u32 s9, s68, 16
  s_load_dword s100, s[16:17], s68
  s_load_dword s101, s[16:17], s9
  v_lshlrev_b32 v5, 4, v0
  v_lshrrev_b32 v6, 4, v0
  v_lshlrev_b32 v6, 7, v6
  v_and_b32 v7, 3, v0
  v_lshl_add_u32 v6, v7, 5, v6
  v_bfe_u32 v7, v0, 2, 2
  v_lshl_add_u32 v8, v7, 2, v6
  s_waitcnt vmcnt(0)
  v_readfirstlane_b32 s79, v4
  s_add_u32 s79, s79, 1
  s_and_b32 s79, s79, 0xff
  s_mul_i32 s80, s79, 0x01010101
  s_xor_b32 s80, s80, 0xffaa5500
  s_lshl_b32 s8, s4, 13
  s_add_u32 s8, s8, 4096
  s_add_u32 s9, s8, 4096
  s_mov_b32 exec_lo, -1
  s_mov_b32 exec_hi, 0x1ffff
L_qpoll_retry:
  buffer_load_dwordx4 v[196:199], v5, s[52:55], s8 offen offset:0 sc1
  buffer_load_dwordx4 v[200:203], v5, s[52:55], s8 offen offset:1024 sc1
  buffer_load_dwordx4 v[204:207], v5, s[52:55], s8 offen offset:2048 sc1
  buffer_load_dwordx4 v[208:211], v5, s[52:55], s8 offen offset:3072 sc1
  buffer_load_dwordx4 v[212:215], v5, s[52:55], s9 offen offset:0 sc1
  buffer_load_dwordx4 v[216:219], v5, s[52:55], s9 offen offset:1024 sc1
  buffer_load_dwordx4 v[220:223], v5, s[52:55], s9 offen offset:2048 sc1
  buffer_load_dwordx4 v[224:227], v5, s[52:55], s9 offen offset:3072 sc1
  s_waitcnt vmcnt(0)
  s_mov_b64 s[12:13], exec
  v_perm_b32 v6, v197, v196, s76
  v_perm_b32 v7, v199, v198, s77
  v_or_b32 v6, v6, v7
  v_cmp_eq_u32 vcc, s80, v6
  s_and_b64 s[12:13], s[12:13], vcc
  v_perm_b32 v6, v201, v200, s76
  v_perm_b32 v7, v203, v202, s77
  v_or_b32 v6, v6, v7
  v_cmp_eq_u32 vcc, s80, v6
  s_and_b64 s[12:13], s[12:13], vcc
  v_perm_b32 v6, v205, v204, s76
  v_perm_b32 v7, v207, v206, s77
  v_or_b32 v6, v6, v7
  v_cmp_eq_u32 vcc, s80, v6
  s_and_b64 s[12:13], s[12:13], vcc
  v_perm_b32 v6, v209, v208, s76
  v_perm_b32 v7, v211, v210, s77
  v_or_b32 v6, v6, v7
  v_cmp_eq_u32 vcc, s80, v6
  s_and_b64 s[12:13], s[12:13], vcc
  v_perm_b32 v6, v213, v212, s76
  v_perm_b32 v7, v215, v214, s77
  v_or_b32 v6, v6, v7
  v_cmp_eq_u32 vcc, s80, v6
  s_and_b64 s[12:13], s[12:13], vcc
  v_perm_b32 v6, v217, v216, s76
  v_perm_b32 v7, v219, v218, s77
  v_or_b32 v6, v6, v7
  v_cmp_eq_u32 vcc, s80, v6
  s_and_b64 s[12:13], s[12:13], vcc
  v_perm_b32 v6, v221, v220, s76
  v_perm_b32 v7, v223, v222, s77
  v_or_b32 v6, v6, v7
  v_cmp_eq_u32 vcc, s80, v6
  s_and_b64 s[12:13], s[12:13], vcc
  v_perm_b32 v6, v225, v224, s76
  v_perm_b32 v7, v227, v226, s77
  v_or_b32 v6, v6, v7
  v_cmp_eq_u32 vcc, s80, v6
  s_and_b64 s[12:13], s[12:13], vcc
  s_cmp_eq_u64 s[12:13], exec
  s_cbranch_scc1 L_qpoll_ok
  s_sub_u32 s78, s78, 1
  s_cmp_eq_u32 s78, 0
  s_cbranch_scc0 L_qpoll_retry
L_qpoll_ok:
  v_and_b32 v196, 0xffffff00, v196
  v_and_b32 v197, 0xffffff00, v197
  v_and_b32 v198, 0xffffff00, v198
  v_and_b32 v199, 0xffffff00, v199
  v_and_b32 v200, 0xffffff00, v200
  v_and_b32 v201, 0xffffff00, v201
  v_and_b32 v202, 0xffffff00, v202
  v_and_b32 v203, 0xffffff00, v203
  v_and_b32 v204, 0xffffff00, v204
  v_and_b32 v205, 0xffffff00, v205
  v_and_b32 v206, 0xffffff00, v206
  v_and_b32 v207, 0xffffff00, v207
  v_and_b32 v208, 0xffffff00, v208
  v_and_b32 v209, 0xffffff00, v209
  v_and_b32 v210, 0xffffff00, v210
  v_and_b32 v211, 0xffffff00, v211
  v_and_b32 v212, 0xffffff00, v212
  v_and_b32 v213, 0xffffff00, v213
  v_and_b32 v214, 0xffffff00, v214
  v_and_b32 v215, 0xffffff00, v215
  v_and_b32 v216, 0xffffff00, v216
  v_and_b32 v217, 0xffffff00, v217
  v_and_b32 v218, 0xffffff00, v218
  v_and_b32 v219, 0xffffff00, v219
  v_and_b32 v220, 0xffffff00, v220
  v_and_b32 v221, 0xffffff00, v221
  v_and_b32 v222, 0xffffff00, v222
  v_and_b32 v223, 0xffffff00, v223
  v_and_b32 v224, 0xffffff00, v224
  v_and_b32 v225, 0xffffff00, v225
  v_and_b32 v226, 0xffffff00, v226
  v_and_b32 v227, 0xffffff00, v227
  s_getreg_b32 s10, hwreg(HW_REG_XCC_ID, 0, 4)
  s_lshl_b32 s10, s10, 8
  s_mov_b64 s[12:13], exec
  v_cmp_eq_u32 vcc, s10, v196
  s_and_b64 s[12:13], s[12:13], vcc
  v_cmp_eq_u32 vcc, s10, v200
  s_and_b64 s[12:13], s[12:13], vcc
  v_cmp_eq_u32 vcc, s10, v204
  s_and_b64 s[12:13], s[12:13], vcc
  v_cmp_eq_u32 vcc, s10, v208
  s_and_b64 s[12:13], s[12:13], vcc
  v_cmp_eq_u32 vcc, s10, v212
  s_and_b64 s[12:13], s[12:13], vcc
  v_cmp_eq_u32 vcc, s10, v216
  s_and_b64 s[12:13], s[12:13], vcc
  v_cmp_eq_u32 vcc, s10, v220
  s_and_b64 s[12:13], s[12:13], vcc
  v_cmp_eq_u32 vcc, s10, v224
  s_and_b64 s[12:13], s[12:13], vcc
  s_bfe_u32 s81, s13, 0x10010
  v_pk_add_f32 v[196:197], v[196:197], v[200:201]
  v_pk_add_f32 v[198:199], v[198:199], v[202:203]
  v_pk_add_f32 v[196:197], v[196:197], v[204:205]
  v_pk_add_f32 v[198:199], v[198:199], v[206:207]
  v_pk_add_f32 v[196:197], v[196:197], v[208:209]
  v_pk_add_f32 v[198:199], v[198:199], v[210:211]
  v_pk_add_f32 v[196:197], v[196:197], v[212:213]
  v_pk_add_f32 v[198:199], v[198:199], v[214:215]
  v_pk_add_f32 v[196:197], v[196:197], v[216:217]
  v_pk_add_f32 v[198:199], v[198:199], v[218:219]
  v_pk_add_f32 v[196:197], v[196:197], v[220:221]
  v_pk_add_f32 v[198:199], v[198:199], v[222:223]
  v_pk_add_f32 v[196:197], v[196:197], v[224:225]
  v_pk_add_f32 v[198:199], v[198:199], v[226:227]
  v_cvt_pk_bf16_f32 v196, v196, v197
  v_cvt_pk_bf16_f32 v197, v198, v199
  s_mov_b32 exec_hi, 0xffff
  ds_write_b32 v8, v196 offset:0
  ds_write_b32 v8, v197 offset:16
  s_mov_b64 exec, 1
  v_mov_b32 v6, s80
  v_mov_b32 v7, s81
  v_mov_b32 v9, 0
  ds_write_b64 v9, v[6:7] offset:384
  s_mov_b64 exec, -1
  s_waitcnt lgkmcnt(0)
  s_branch L_bar0
L_qproj:
  s_setprio 3
  v_lshlrev_b32 v5, 4, v0
  v_mul_u32_u24 v6, 20, v2
  s_mov_b32 s12, s4
  s_mov_b32 s13, s5
  s_mul_i32 s9, s13, 983040
  s_mul_i32 s10, s12, 384
  s_add_u32 s9, s9, s10
  s_lshl_b32 s7, s12, 3
  s_add_u32 s7, s7, s13
  s_sub_u32 s15, s3, 5
  s_lshl_b32 s10, s15, 7
  s_add_u32 s9, s9, s10
  v_mul_u32_u24 v7, 122880, v2
  v_lshl_add_u32 v7, v3, 4, v7
  s_mul_i32 s11, s13, 160
  s_waitcnt lgkmcnt(0)
  s_add_u32 s60, s22, s9
  s_addc_u32 s61, s23, 0
  s_mov_b32 s62, 970880
  s_mov_b32 s63, 0x20000
  s_mov_b32 s56, s16
  s_mov_b32 s57, s17
  s_mov_b32 s58, 1280
  s_mov_b32 s59, 0x20000
  buffer_load_dwordx4 v[8:11], v5, s[56:59], 0 offen
  buffer_load_dwordx4 v[12:15], v5, s[56:59], 0 offen offset:1024
  buffer_load_dwordx4 v[16:19], v6, s[56:59], s11 offen
  buffer_load_dword v20, v6, s[56:59], s11 offen offset:16
  s_mov_b32 s11, 0
  buffer_load_dwordx4 v[64:67], v7, s[60:63], s11 offen nt
  s_mov_b32 s11, 12288
  buffer_load_dwordx4 v[68:71], v7, s[60:63], s11 offen nt
  s_mov_b32 s11, 24576
  buffer_load_dwordx4 v[72:75], v7, s[60:63], s11 offen nt
  s_mov_b32 s11, 36864
  buffer_load_dwordx4 v[76:79], v7, s[60:63], s11 offen nt
  s_mov_b32 s11, 49152
  buffer_load_dwordx4 v[80:83], v7, s[60:63], s11 offen nt
  s_mov_b32 s11, 61440
  buffer_load_dwordx4 v[84:87], v7, s[60:63], s11 offen nt
  s_mov_b32 s11, 73728
  buffer_load_dwordx4 v[88:91], v7, s[60:63], s11 offen nt
  s_mov_b32 s11, 86016
  buffer_load_dwordx4 v[92:95], v7, s[60:63], s11 offen nt
  s_mov_b32 s11, 98304
  buffer_load_dwordx4 v[96:99], v7, s[60:63], s11 offen nt
  s_mov_b32 s11, 110592
  buffer_load_dwordx4 v[100:103], v7, s[60:63], s11 offen nt
  s_mov_b32 s52, s40
  s_mov_b32 s53, s41
  s_mov_b32 s54, 1081344
  s_mov_b32 s55, 0x20000
  buffer_load_dword v4, off, s[52:55], 0 sc1
  s_barrier
  s_add_u32 s44, s18, s8
  s_addc_u32 s45, s19, 0
  s_mov_b32 s46, 196608
  s_mov_b32 s47, 0x20000
  s_add_u32 s48, s20, s8
  s_addc_u32 s49, s21, 0
  s_mov_b32 s50, 196608
  s_mov_b32 s51, 0x20000
  s_lshl_b32 s6, s4, 3
  s_add_u32 s6, s6, s5
  s_mov_b32 s72, 0x07060500
  s_mov_b32 s73, 0x07060501
  s_mov_b32 s74, 0x07060502
  s_mov_b32 s75, 0x07060503
  s_mov_b32 s76, 0x0c0c0400
  s_mov_b32 s77, 0x04000c0c
  s_mov_b32 s78, 1048576
  s_lshr_b32 s42, s5, 1
  s_and_b32 s43, s5, 1
  s_cmp_lt_u32 s2, 160
  s_cselect_b32 s39, 1, 0
  s_min_u32 s13, s2, 159
  s_mov_b32 s38, s13
  s_cmp_ge_u32 s13, 80
  s_cselect_b32 s14, 1, 0
  s_mul_i32 s12, s14, 80
  s_sub_u32 s12, s13, s12
  s_mul_i32 s68, s14, 320
  s_lshr_b32 s69, s12, 4
  s_lshl_b32 s69, s69, 6
  s_add_u32 s68, s68, s69
  s_and_b32 s69, s12, 3
  s_lshl_b32 s69, s69, 4
  s_add_u32 s68, s68, s69
  s_bfe_u32 s69, s12, 0x20002
  s_lshl_b32 s69, s69, 1
  s_add_u32 s68, s68, s69
  s_lshl_b32 s68, s68, 1
  s_waitcnt vmcnt(13)
  v_mov_b32 v44, 0
  v_mov_b32 v45, 0
  v_mov_b32 v46, 0x3f803f80
  v_dot2c_f32_bf16 v44, v8, v46
  v_dot2c_f32_bf16 v45, v8, v8
  v_dot2c_f32_bf16 v44, v9, v46
  v_dot2c_f32_bf16 v45, v9, v9
  v_dot2c_f32_bf16 v44, v10, v46
  v_dot2c_f32_bf16 v45, v10, v10
  v_dot2c_f32_bf16 v44, v11, v46
  v_dot2c_f32_bf16 v45, v11, v11
  v_dot2c_f32_bf16 v44, v12, v46
  v_dot2c_f32_bf16 v45, v12, v12
  v_dot2c_f32_bf16 v44, v13, v46
  v_dot2c_f32_bf16 v45, v13, v13
  v_dot2c_f32_bf16 v44, v14, v46
  v_dot2c_f32_bf16 v45, v14, v14
  v_dot2c_f32_bf16 v44, v15, v46
  v_dot2c_f32_bf16 v45, v15, v15
  s_nop 1
  v_add_f32_dpp v44, v44, v44 row_shr:1 row_mask:0xf bank_mask:0xf bound_ctrl:0
  v_add_f32_dpp v45, v45, v45 row_shr:1 row_mask:0xf bank_mask:0xf bound_ctrl:0
  s_nop 0
  v_add_f32_dpp v44, v44, v44 row_shr:2 row_mask:0xf bank_mask:0xf bound_ctrl:0
  v_add_f32_dpp v45, v45, v45 row_shr:2 row_mask:0xf bank_mask:0xf bound_ctrl:0
  s_nop 0
  v_add_f32_dpp v44, v44, v44 row_shr:4 row_mask:0xf bank_mask:0xf bound_ctrl:0
  v_add_f32_dpp v45, v45, v45 row_shr:4 row_mask:0xf bank_mask:0xf bound_ctrl:0
  s_nop 0
  v_add_f32_dpp v44, v44, v44 row_shr:8 row_mask:0xf bank_mask:0xf bound_ctrl:0
  v_add_f32_dpp v45, v45, v45 row_shr:8 row_mask:0xf bank_mask:0xf bound_ctrl:0
  s_nop 0
  v_add_f32_dpp v44, v44, v44 row_bcast:15 row_mask:0xa bank_mask:0xf
  v_add_f32_dpp v45, v45, v45 row_bcast:15 row_mask:0xa bank_mask:0xf
  s_nop 0
  v_add_f32_dpp v44, v44, v44 row_bcast:31 row_mask:0xc bank_mask:0xf
  v_add_f32_dpp v45, v45, v45 row_bcast:31 row_mask:0xc bank_mask:0xf
  v_readlane_b32 s10, v44, 63
  v_readlane_b32 s11, v45, 63
  v_mov_b32 v46, 0x3acccccd
  v_mul_f32 v44, s10, v46
  v_mul_f32 v46, s11, v46
  v_fma_f32 v46, -v44, v44, v46
  v_max_f32 v46, 0, v46
  v_cvt_pk_bf16_f32 v45, v44, v46
  v_lshlrev_b32 v44, 16, v45
  v_and_b32 v46, 0xffff0000, v45
  v_add_f32 v46, 0x3727c5ac, v46
  v_cvt_pk_bf16_f32 v46, v46, v46
  v_and_b32 v46, 0xffff0000, v46
  v_sqrt_f32 v46, v46
  s_nop 0
  v_cvt_pk_bf16_f32 v46, v46, v46
  v_and_b32 v46, 0xffff0000, v46
  v_rcp_f32 v46, v46
  s_waitcnt vmcnt(11)
  v_lshlrev_b32 v32, 16, v16
  v_and_b32 v33, 0xffff0000, v16
  v_lshlrev_b32 v34, 16, v17
  v_and_b32 v35, 0xffff0000, v17
  v_lshlrev_b32 v36, 16, v18
  v_and_b32 v37, 0xffff0000, v18
  v_lshlrev_b32 v38, 16, v19
  v_and_b32 v39, 0xffff0000, v19
  v_lshlrev_b32 v40, 16, v20
  v_and_b32 v41, 0xffff0000, v20
  v_sub_f32 v32, v32, v44
  v_sub_f32 v33, v33, v44
  v_sub_f32 v34, v34, v44
  v_sub_f32 v35, v35, v44
  v_sub_f32 v36, v36, v44
  v_sub_f32 v37, v37, v44
  v_sub_f32 v38, v38, v44
  v_sub_f32 v39, v39, v44
  v_sub_f32 v40, v40, v44
  v_sub_f32 v41, v41, v44
  v_cvt_pk_bf16_f32 v45, v32, v33
  v_lshlrev_b32 v32, 16, v45
  v_and_b32 v33, 0xffff0000, v45
  v_cvt_pk_bf16_f32 v45, v34, v35
  v_lshlrev_b32 v34, 16, v45
  v_and_b32 v35, 0xffff0000, v45
  v_cvt_pk_bf16_f32 v45, v36, v37
  v_lshlrev_b32 v36, 16, v45
  v_and_b32 v37, 0xffff0000, v45
  v_cvt_pk_bf16_f32 v45, v38, v39
  v_lshlrev_b32 v38, 16, v45
  v_and_b32 v39, 0xffff0000, v45
  v_cvt_pk_bf16_f32 v45, v40, v41
  v_lshlrev_b32 v40, 16, v45
  v_and_b32 v41, 0xffff0000, v45
  v_mul_f32 v32, v32, v46
  v_mul_f32 v33, v33, v46
  v_mul_f32 v34, v34, v46
  v_mul_f32 v35, v35, v46
  v_mul_f32 v36, v36, v46
  v_mul_f32 v37, v37, v46
  v_mul_f32 v38, v38, v46
  v_mul_f32 v39, v39, v46
  v_mul_f32 v40, v40, v46
  v_mul_f32 v41, v41, v46
  v_cvt_pk_bf16_f32 v16, v32, 0
  v_cvt_pk_bf16_f32 v32, 0, v32
  v_cvt_pk_bf16_f32 v17, v33, 0
  v_cvt_pk_bf16_f32 v33, 0, v33
  v_cvt_pk_bf16_f32 v18, v34, 0
  v_cvt_pk_bf16_f32 v34, 0, v34
  v_cvt_pk_bf16_f32 v19, v35, 0
  v_cvt_pk_bf16_f32 v35, 0, v35
  v_cvt_pk_bf16_f32 v20, v36, 0
  v_cvt_pk_bf16_f32 v36, 0, v36
  v_cvt_pk_bf16_f32 v21, v37, 0
  v_cvt_pk_bf16_f32 v37, 0, v37
  v_cvt_pk_bf16_f32 v22, v38, 0
  v_cvt_pk_bf16_f32 v38, 0, v38
  v_cvt_pk_bf16_f32 v23, v39, 0
  v_cvt_pk_bf16_f32 v39, 0, v39
  v_cvt_pk_bf16_f32 v24, v40, 0
  v_cvt_pk_bf16_f32 v40, 0, v40
  v_cvt_pk_bf16_f32 v25, v41, 0
  v_cvt_pk_bf16_f32 v41, 0, v41
  v_mov_b32 v44, 0
  v_mov_b32 v45, 0
  v_mov_b32 v46, 0
  v_mov_b32 v47, 0
  v_mov_b32 v48, 0
  v_mov_b32 v49, 0
  v_mov_b32 v50, 0
  v_mov_b32 v51, 0
  v_bfe_u32 v53, v0, 1, 2
  v_lshrrev_b32 v54, 4, v0
  v_lshl_add_u32 v53, v54, 2, v53
  v_lshlrev_b32 v53, 4, v53
  s_lshl_b32 s11, s6, 10
  s_add_u32 s11, s11, 4096
  s_lshl_b32 s8, s7, 10
  s_add_u32 s8, s8, 4096
  s_lshl_b32 s9, s15, 8
  s_add_u32 s8, s8, s9
  s_waitcnt vmcnt(10)
  v_dot2c_f32_bf16 v44, v64, v16
  v_dot2c_f32_bf16 v45, v64, v32
  v_dot2c_f32_bf16 v46, v65, v16
  v_dot2c_f32_bf16 v47, v65, v32
  v_dot2c_f32_bf16 v48, v66, v16
  v_dot2c_f32_bf16 v49, v66, v32
  v_dot2c_f32_bf16 v50, v67, v16
  v_dot2c_f32_bf16 v51, v67, v32
  s_waitcnt vmcnt(9)
  v_dot2c_f32_bf16 v44, v68, v17
  v_dot2c_f32_bf16 v45, v68, v33
  v_dot2c_f32_bf16 v46, v69, v17
  v_dot2c_f32_bf16 v47, v69, v33
  v_dot2c_f32_bf16 v48, v70, v17
  v_dot2c_f32_bf16 v49, v70, v33
  v_dot2c_f32_bf16 v50, v71, v17
  v_dot2c_f32_bf16 v51, v71, v33
  s_waitcnt vmcnt(8)
  v_dot2c_f32_bf16 v44, v72, v18
  v_dot2c_f32_bf16 v45, v72, v34
  v_dot2c_f32_bf16 v46, v73, v18
  v_dot2c_f32_bf16 v47, v73, v34
  v_dot2c_f32_bf16 v48, v74, v18
  v_dot2c_f32_bf16 v49, v74, v34
  v_dot2c_f32_bf16 v50, v75, v18
  v_dot2c_f32_bf16 v51, v75, v34
  s_waitcnt vmcnt(7)
  v_dot2c_f32_bf16 v44, v76, v19
  v_dot2c_f32_bf16 v45, v76, v35
  v_dot2c_f32_bf16 v46, v77, v19
  v_dot2c_f32_bf16 v47, v77, v35
  v_dot2c_f32_bf16 v48, v78, v19
  v_dot2c_f32_bf16 v49, v78, v35
  v_dot2c_f32_bf16 v50, v79, v19
  v_dot2c_f32_bf16 v51, v79, v35
  s_waitcnt vmcnt(6)
  v_dot2c_f32_bf16 v44, v80, v20
  v_dot2c_f32_bf16 v45, v80, v36
  v_dot2c_f32_bf16 v46, v81, v20
  v_dot2c_f32_bf16 v47, v81, v36
  v_dot2c_f32_bf16 v48, v82, v20
  v_dot2c_f32_bf16 v49, v82, v36
  v_dot2c_f32_bf16 v50, v83, v20
  v_dot2c_f32_bf16 v51, v83, v36
  s_waitcnt vmcnt(5)
  v_dot2c_f32_bf16 v44, v84, v21
  v_dot2c_f32_bf16 v45, v84, v37
  v_dot2c_f32_bf16 v46, v85, v21
  v_dot2c_f32_bf16 v47, v85, v37
  v_dot2c_f32_bf16 v48, v86, v21
  v_dot2c_f32_bf16 v49, v86, v37
  v_dot2c_f32_bf16 v50, v87, v21
  v_dot2c_f32_bf16 v51, v87, v37
  s_waitcnt vmcnt(4)
  v_dot2c_f32_bf16 v44, v88, v22
  v_dot2c_f32_bf16 v45, v88, v38
  v_dot2c_f32_bf16 v46, v89, v22
  v_dot2c_f32_bf16 v47, v89, v38
  v_dot2c_f32_bf16 v48, v90, v22
  v_dot2c_f32_bf16 v49, v90, v38
  v_dot2c_f32_bf16 v50, v91, v22
  v_dot2c_f32_bf16 v51, v91, v38
  s_waitcnt vmcnt(3)
  v_dot2c_f32_bf16 v44, v92, v23
  v_dot2c_f32_bf16 v45, v92, v39
  v_dot2c_f32_bf16 v46, v93, v23
  v_dot2c_f32_bf16 v47, v93, v39
  v_dot2c_f32_bf16 v48, v94, v23
  v_dot2c_f32_bf16 v49, v94, v39
  v_dot2c_f32_bf16 v50, v95, v23
  v_dot2c_f32_bf16 v51, v95, v39
  s_waitcnt vmcnt(2)
  v_dot2c_f32_bf16 v44, v96, v24
  v_dot2c_f32_bf16 v45, v96, v40
  v_dot2c_f32_bf16 v46, v97, v24
  v_dot2c_f32_bf16 v47, v97, v40
  v_dot2c_f32_bf16 v48, v98, v24
  v_dot2c_f32_bf16 v49, v98, v40
  v_dot2c_f32_bf16 v50, v99, v24
  v_dot2c_f32_bf16 v51, v99, v40
  s_waitcnt vmcnt(1)
  v_dot2c_f32_bf16 v44, v100, v25
  v_dot2c_f32_bf16 v45, v100, v41
  v_dot2c_f32_bf16 v46, v101, v25
  v_dot2c_f32_bf16 v47, v101, v41
  v_dot2c_f32_bf16 v48, v102, v25
  v_dot2c_f32_bf16 v49, v102, v41
  v_dot2c_f32_bf16 v50, v103, v25
  v_dot2c_f32_bf16 v51, v103, v41
  s_waitcnt vmcnt(0)
  v_readfirstlane_b32 s79, v4
  s_add_u32 s79, s79, 1
  s_and_b32 s79, s79, 0xff
  s_mul_i32 s80, s79, 0x01010101
  s_xor_b32 s80, s80, 0xffaa5500
  v_permlane32_swap_b32 v44, v48
  v_permlane32_swap_b32 v45, v49
  v_permlane32_swap_b32 v46, v50
  v_permlane32_swap_b32 v47, v51
  v_add_f32 v44, v44, v48
  v_add_f32 v45, v45, v49
  v_add_f32 v46, v46, v50
  v_add_f32 v47, v47, v51
  s_nop 0
  v_permlane16_swap_b32 v44, v46
  v_permlane16_swap_b32 v45, v47
  v_add_f32 v44, v44, v46
  v_add_f32 v45, v45, v47
  s_nop 0
  v_add_f32_dpp v44, v44, v44 row_ror:8 row_mask:0xf bank_mask:0xf
  v_add_f32_dpp v45, v45, v45 row_ror:8 row_mask:0xf bank_mask:0xf
  v_mov_b32 v52, s80
  v_mov_b32_dpp v46, v44 quad_perm:[1,1,3,3] row_mask:0xf bank_mask:0xf
  v_mov_b32_dpp v47, v45 quad_perm:[1,1,3,3] row_mask:0xf bank_mask:0xf
  v_perm_b32 v44, v44, v52, s72
  v_perm_b32 v45, v45, v52, s73
  v_perm_b32 v46, v46, v52, s74
  v_perm_b32 v47, v47, v52, s75
  s_mov_b32 exec_lo, 0x00550055
  s_mov_b32 exec_hi, 0x00550055
  buffer_store_dwordx4 v[44:47], v53, s[52:55], s8 offen sc1
  s_mov_b64 exec, -1
  s_cmp_eq_u32 s3, 5
  s_cbranch_scc0 L_noxcc
  s_getreg_b32 s10, hwreg(HW_REG_XCC_ID, 0, 4)
  s_lshl_b32 s10, s10, 8
  v_mov_b32 v48, s10
  v_mov_b32 v49, s10
  v_mov_b32 v50, s10
  v_mov_b32 v51, s10
  v_perm_b32 v48, v48, v52, s72
  v_perm_b32 v49, v49, v52, s73
  v_perm_b32 v50, v50, v52, s74
  v_perm_b32 v51, v51, v52, s75
  s_mov_b64 exec, 1
  buffer_store_dwordx4 v[48:51], off, s[52:55], s11 offset:768 sc1
  s_mov_b64 exec, -1
L_noxcc:
  s_setprio 0
  s_add_u32 s8, s70, 0
  s_and_b32 s8, s8, 63
  s_mul_i32 s8, s8, 3072
  buffer_load_dwordx4 v[64:67], v1, s[44:47], s8 offen offset:0 nt
  buffer_load_dwordx4 v[68:71], v1, s[44:47], s8 offen offset:128 nt
  buffer_load_dwordx4 v[72:75], v1, s[44:47], s8 offen offset:256 nt
  s_add_u32 s8, s70, 8
  s_and_b32 s8, s8, 63
  s_mul_i32 s8, s8, 3072
  buffer_load_dwordx4 v[76:79], v1, s[44:47], s8 offen offset:0 nt
  buffer_load_dwordx4 v[80:83], v1, s[44:47], s8 offen offset:128 nt
  buffer_load_dwordx4 v[84:87], v1, s[44:47], s8 offen offset:256 nt
  s_add_u32 s8, s70, 16
  s_and_b32 s8, s8, 63
  s_mul_i32 s8, s8, 3072
  buffer_load_dwordx4 v[88:91], v1, s[44:47], s8 offen offset:0 nt
  buffer_load_dwordx4 v[92:95], v1, s[44:47], s8 offen offset:128 nt
  buffer_load_dwordx4 v[96:99], v1, s[44:47], s8 offen offset:256 nt
  s_add_u32 s8, s70, 24
  s_and_b32 s8, s8, 63
  s_mul_i32 s8, s8, 3072
  buffer_load_dwordx4 v[100:103], v1, s[44:47], s8 offen offset:0 nt
  buffer_load_dwordx4 v[104:107], v1, s[44:47], s8 offen offset:128 nt
  buffer_load_dwordx4 v[108:111], v1, s[44:47], s8 offen offset:256 nt
  s_add_u32 s8, s70, 32
  s_and_b32 s8, s8, 63
  s_mul_i32 s8, s8, 3072
  buffer_load_dwordx4 v[112:115], v1, s[44:47], s8 offen offset:0 nt
  buffer_load_dwordx4 v[116:119], v1, s[44:47], s8 offen offset:128 nt
  buffer_load_dwordx4 v[120:123], v1, s[44:47], s8 offen offset:256 nt
  s_add_u32 s8, s70, 40
  s_and_b32 s8, s8, 63
  s_mul_i32 s8, s8, 3072
  buffer_load_dwordx4 v[124:127], v1, s[44:47], s8 offen offset:0 nt
  buffer_load_dwordx4 v[128:131], v1, s[44:47], s8 offen offset:128 nt
  buffer_load_dwordx4 v[132:135], v1, s[44:47], s8 offen offset:256 nt
  s_add_u32 s8, s70, 48
  s_and_b32 s8, s8, 63
  s_mul_i32 s8, s8, 3072
  buffer_load_dwordx4 v[136:139], v1, s[44:47], s8 offen offset:0 nt
  buffer_load_dwordx4 v[140:143], v1, s[44:47], s8 offen offset:128 nt
  buffer_load_dwordx4 v[144:147], v1, s[44:47], s8 offen offset:256 nt
  s_add_u32 s8, s70, 56
  s_and_b32 s8, s8, 63
  s_mul_i32 s8, s8, 3072
  buffer_load_dwordx4 v[148:151], v1, s[44:47], s8 offen offset:0 nt
  buffer_load_dwordx4 v[152:155], v1, s[44:47], s8 offen offset:128 nt
  buffer_load_dwordx4 v[156:159], v1, s[44:47], s8 offen offset:256 nt
  s_add_u32 s8, s70, 0
  s_and_b32 s8, s8, 63
  s_mul_i32 s8, s8, 3072
  buffer_load_dwordx4 v[160:163], v1, s[48:51], s8 offen offset:0 nt
  buffer_load_dwordx4 v[164:167], v1, s[48:51], s8 offen offset:128 nt
  buffer_load_dwordx4 v[168:171], v1, s[48:51], s8 offen offset:256 nt
  s_add_u32 s8, s70, 8
  s_and_b32 s8, s8, 63
  s_mul_i32 s8, s8, 3072
  buffer_load_dwordx4 v[172:175], v1, s[48:51], s8 offen offset:0 nt
  buffer_load_dwordx4 v[176:179], v1, s[48:51], s8 offen offset:128 nt
  buffer_load_dwordx4 v[180:183], v1, s[48:51], s8 offen offset:256 nt
  s_add_u32 s8, s70, 16
  s_and_b32 s8, s8, 63
  s_mul_i32 s8, s8, 3072
  buffer_load_dwordx4 v[184:187], v1, s[48:51], s8 offen offset:0 nt
  buffer_load_dwordx4 v[188:191], v1, s[48:51], s8 offen offset:128 nt
  buffer_load_dwordx4 v[192:195], v1, s[48:51], s8 offen offset:256 nt
L_bar0:
  s_nop 4
  v_lshrrev_b32 v61, 4, v0
  s_lshl_b32 s8, s3, 10
  v_add_u32 v62, 0, v3
  v_mul_u32_u24 v63, 43, v62
  v_lshrrev_b32 v63, 8, v63
  v_mul_u32_u24 v57, 6, v63
  v_sub_u32 v62, v62, v57
  v_lshlrev_b32 v63, 3, v63
  v_lshl_add_u32 v63, v61, 1, v63
  v_lshl_add_u32 v63, v63, 3, v62
  v_lshlrev_b32 v63, 2, v63
  v_add_u32 v58, s8, v63
  v_add_u32 v62, 8, v3
  v_mul_u32_u24 v63, 43, v62
  v_lshrrev_b32 v63, 8, v63
  v_mul_u32_u24 v57, 6, v63
  v_sub_u32 v62, v62, v57
  v_lshlrev_b32 v63, 3, v63
  v_lshl_add_u32 v63, v61, 1, v63
  v_lshl_add_u32 v63, v63, 3, v62
  v_lshlrev_b32 v63, 2, v63
  v_add_u32 v59, s8, v63
  v_add_u32 v62, 16, v3
  v_mul_u32_u24 v63, 43, v62
  v_lshrrev_b32 v63, 8, v63
  v_mul_u32_u24 v57, 6, v63
  v_sub_u32 v62, v62, v57
  v_lshlrev_b32 v63, 3, v63
  v_lshl_add_u32 v63, v61, 1, v63
  v_lshl_add_u32 v63, v63, 3, v62
  v_lshlrev_b32 v63, 2, v63
  v_add_u32 v60, s8, v63
  v_lshlrev_b32 v61, 5, v0
  v_add_u32 v61, s8, v61
  s_mul_i32 s11, s4, 192
  s_mul_i32 s12, s42, 48
  s_add_u32 s11, s11, s12
  s_mul_i32 s11, s11, 1280
  s_mul_i32 s12, s43, 640
  s_add_u32 s11, s11, s12
  s_lshl_b32 s12, s3, 7
  s_add_u32 s11, s11, s12
  s_add_u32 s60, s24, s11
  s_addc_u32 s61, s25, 0
  s_mov_b32 s62, 0
  s_mov_b32 s63, 0x20000
  s_mov_b32 s64, s60
  s_mov_b32 s65, s61
  s_mov_b32 s66, 0
  s_mov_b32 s67, 0x20000
  v_mul_u32_u24 v7, 1280, v2
  v_lshl_add_u32 v7, v3, 4, v7
  s_mov_b32 s9, 10240
  s_mov_b32 s10, 30720
  v_mov_b32 v63, v7
  s_cmp_eq_u32 s3, 4
  s_cbranch_scc0 L_p1_a
  s_mov_b32 s62, 60288
  s_mov_b32 s66, 60288
  s_branch L_p1_go
L_p1_a:
  s_cmp_eq_u32 s3, 5
  s_cbranch_scc0 L_p1_b
  s_mov_b32 s60, s28
  s_mov_b32 s61, s29
  s_mov_b32 s62, 3072
  s_mov_b32 s64, s30
  s_mov_b32 s65, s31
  s_mov_b32 s66, 3072
  s_mov_b32 s9, 1024
  s_mov_b32 s10, 0
  v_lshlrev_b32 v63, 4, v0
  s_branch L_p1_go
L_p1_b:
  s_cmp_eq_u32 s3, 6
  s_cbranch_scc0 L_p1_go
  s_mov_b32 s60, s32
  s_mov_b32 s61, s33
  s_mov_b32 s62, 3072
  s_mov_b32 s9, 1024
  s_mov_b32 s10, 0
  v_lshlrev_b32 v63, 4, v0
L_p1_go:
  s_barrier
  v_lshlrev_b32 v5, 4, v3
  ds_read_b128 v[8:11], v5 offset:0
  ds_read_b128 v[12:15], v5 offset:128
  ds_read_b128 v[16:19], v5 offset:256
  v_mov_b32 v57, 0
  ds_read_b64 v[56:57], v57 offset:384
  s_waitcnt lgkmcnt(0)
  v_readfirstlane_b32 s80, v56
  v_readfirstlane_b32 s81, v57
  v_mov_b32 v24, 0
  v_mov_b32 v25, 0
  s_waitcnt vmcnt(27)
  v_dot2c_f32_bf16 v24, v64, v8
  v_dot2c_f32_bf16 v25, v76, v8
  v_dot2c_f32_bf16 v24, v65, v9
  v_dot2c_f32_bf16 v25, v77, v9
  v_dot2c_f32_bf16 v24, v66, v10
  v_dot2c_f32_bf16 v25, v78, v10
  v_dot2c_f32_bf16 v24, v67, v11
  v_dot2c_f32_bf16 v25, v79, v11
  v_dot2c_f32_bf16 v24, v68, v12
  v_dot2c_f32_bf16 v25, v80, v12
  v_dot2c_f32_bf16 v24, v69, v13
  v_dot2c_f32_bf16 v25, v81, v13
  v_dot2c_f32_bf16 v24, v70, v14
  v_dot2c_f32_bf16 v25, v82, v14
  v_dot2c_f32_bf16 v24, v71, v15
  v_dot2c_f32_bf16 v25, v83, v15
  v_dot2c_f32_bf16 v24, v72, v16
  v_dot2c_f32_bf16 v25, v84, v16
  v_dot2c_f32_bf16 v24, v73, v17
  v_dot2c_f32_bf16 v25, v85, v17
  v_dot2c_f32_bf16 v24, v74, v18
  v_dot2c_f32_bf16 v25, v86, v18
  v_dot2c_f32_bf16 v24, v75, v19
  v_dot2c_f32_bf16 v25, v87, v19
  s_nop 1
  v_add_f32_dpp v24, v24, v24 quad_perm:[1,0,3,2] row_mask:0xf bank_mask:0xf
  v_add_f32_dpp v25, v25, v25 quad_perm:[1,0,3,2] row_mask:0xf bank_mask:0xf
  s_nop 0
  v_add_f32_dpp v24, v24, v24 quad_perm:[2,3,0,1] row_mask:0xf bank_mask:0xf
  v_add_f32_dpp v25, v25, v25 quad_perm:[2,3,0,1] row_mask:0xf bank_mask:0xf
  s_nop 0
  v_add_f32_dpp v24, v24, v24 row_half_mirror row_mask:0xf bank_mask:0xf
  v_add_f32_dpp v25, v25, v25 row_half_mirror row_mask:0xf bank_mask:0xf
  v_cvt_pk_bf16_f32 v56, v24, v25
  v_lshlrev_b32 v24, 16, v56
  v_and_b32 v25, 0xffff0000, v56
  v_mul_f32 v24, 0x3d93cd3a, v24
  v_mul_f32 v25, 0x3d93cd3a, v25
  v_cvt_pk_bf16_f32 v56, v24, v25
  v_lshlrev_b32 v24, 16, v56
  v_and_b32 v25, 0xffff0000, v56
  v_mov_b32 v26, 0
  v_mov_b32 v27, 0
  s_waitcnt vmcnt(21)
  v_dot2c_f32_bf16 v26, v88, v8
  v_dot2c_f32_bf16 v27, v100, v8
  v_dot2c_f32_bf16 v26, v89, v9
  v_dot2c_f32_bf16 v27, v101, v9
  v_dot2c_f32_bf16 v26, v90, v10
  v_dot2c_f32_bf16 v27, v102, v10
  v_dot2c_f32_bf16 v26, v91, v11
  v_dot2c_f32_bf16 v27, v103, v11
  v_dot2c_f32_bf16 v26, v92, v12
  v_dot2c_f32_bf16 v27, v104, v12
  v_dot2c_f32_bf16 v26, v93, v13
  v_dot2c_f32_bf16 v27, v105, v13
  v_dot2c_f32_bf16 v26, v94, v14
  v_dot2c_f32_bf16 v27, v106, v14
  v_dot2c_f32_bf16 v26, v95, v15
  v_dot2c_f32_bf16 v27, v107, v15
  v_dot2c_f32_bf16 v26, v96, v16
  v_dot2c_f32_bf16 v27, v108, v16
  v_dot2c_f32_bf16 v26, v97, v17
  v_dot2c_f32_bf16 v27, v109, v17
  v_dot2c_f32_bf16 v26, v98, v18
  v_dot2c_f32_bf16 v27, v110, v18
  v_dot2c_f32_bf16 v26, v99, v19
  v_dot2c_f32_bf16 v27, v111, v19
  s_nop 1
  v_add_f32_dpp v26, v26, v26 quad_perm:[1,0,3,2] row_mask:0xf bank_mask:0xf
  v_add_f32_dpp v27, v27, v27 quad_perm:[1,0,3,2] row_mask:0xf bank_mask:0xf
  s_nop 0
  v_add_f32_dpp v26, v26, v26 quad_perm:[2,3,0,1] row_mask:0xf bank_mask:0xf
  v_add_f32_dpp v27, v27, v27 quad_perm:[2,3,0,1] row_mask:0xf bank_mask:0xf
  s_nop 0
  v_add_f32_dpp v26, v26, v26 row_half_mirror row_mask:0xf bank_mask:0xf
  v_add_f32_dpp v27, v27, v27 row_half_mirror row_mask:0xf bank_mask:0xf
  v_cvt_pk_bf16_f32 v56, v26, v27
  v_lshlrev_b32 v26, 16, v56
  v_and_b32 v27, 0xffff0000, v56
  v_mul_f32 v26, 0x3d93cd3a, v26
  v_mul_f32 v27, 0x3d93cd3a, v27
  v_cvt_pk_bf16_f32 v56, v26, v27
  v_lshlrev_b32 v26, 16, v56
  v_and_b32 v27, 0xffff0000, v56
  v_mov_b32 v28, 0
  v_mov_b32 v29, 0
  s_waitcnt vmcnt(15)
  v_dot2c_f32_bf16 v28, v112, v8
  v_dot2c_f32_bf16 v29, v124, v8
  v_dot2c_f32_bf16 v28, v113, v9
  v_dot2c_f32_bf16 v29, v125, v9
  v_dot2c_f32_bf16 v28, v114, v10
  v_dot2c_f32_bf16 v29, v126, v10
  v_dot2c_f32_bf16 v28, v115, v11
  v_dot2c_f32_bf16 v29, v127, v11
  v_dot2c_f32_bf16 v28, v116, v12
  v_dot2c_f32_bf16 v29, v128, v12
  v_dot2c_f32_bf16 v28, v117, v13
  v_dot2c_f32_bf16 v29, v129, v13
  v_dot2c_f32_bf16 v28, v118, v14
  v_dot2c_f32_bf16 v29, v130, v14
  v_dot2c_f32_bf16 v28, v119, v15
  v_dot2c_f32_bf16 v29, v131, v15
  v_dot2c_f32_bf16 v28, v120, v16
  v_dot2c_f32_bf16 v29, v132, v16
  v_dot2c_f32_bf16 v28, v121, v17
  v_dot2c_f32_bf16 v29, v133, v17
  v_dot2c_f32_bf16 v28, v122, v18
  v_dot2c_f32_bf16 v29, v134, v18
  v_dot2c_f32_bf16 v28, v123, v19
  v_dot2c_f32_bf16 v29, v135, v19
  s_nop 1
  v_add_f32_dpp v28, v28, v28 quad_perm:[1,0,3,2] row_mask:0xf bank_mask:0xf
  v_add_f32_dpp v29, v29, v29 quad_perm:[1,0,3,2] row_mask:0xf bank_mask:0xf
  s_nop 0
  v_add_f32_dpp v28, v28, v28 quad_perm:[2,3,0,1] row_mask:0xf bank_mask:0xf
  v_add_f32_dpp v29, v29, v29 quad_perm:[2,3,0,1] row_mask:0xf bank_mask:0xf
  s_nop 0
  v_add_f32_dpp v28, v28, v28 row_half_mirror row_mask:0xf bank_mask:0xf
  v_add_f32_dpp v29, v29, v29 row_half_mirror row_mask:0xf bank_mask:0xf
  v_cvt_pk_bf16_f32 v56, v28, v29
  v_lshlrev_b32 v28, 16, v56
  v_and_b32 v29, 0xffff0000, v56
  v_mul_f32 v28, 0x3d93cd3a, v28
  v_mul_f32 v29, 0x3d93cd3a, v29
  v_cvt_pk_bf16_f32 v56, v28, v29
  v_lshlrev_b32 v28, 16, v56
  v_and_b32 v29, 0xffff0000, v56
  v_mov_b32 v30, 0
  v_mov_b32 v31, 0
  s_waitcnt vmcnt(9)
  v_dot2c_f32_bf16 v30, v136, v8
  v_dot2c_f32_bf16 v31, v148, v8
  v_dot2c_f32_bf16 v30, v137, v9
  v_dot2c_f32_bf16 v31, v149, v9
  v_dot2c_f32_bf16 v30, v138, v10
  v_dot2c_f32_bf16 v31, v150, v10
  v_dot2c_f32_bf16 v30, v139, v11
  v_dot2c_f32_bf16 v31, v151, v11
  v_dot2c_f32_bf16 v30, v140, v12
  v_dot2c_f32_bf16 v31, v152, v12
  v_dot2c_f32_bf16 v30, v141, v13
  v_dot2c_f32_bf16 v31, v153, v13
  v_dot2c_f32_bf16 v30, v142, v14
  v_dot2c_f32_bf16 v31, v154, v14
  v_dot2c_f32_bf16 v30, v143, v15
  v_dot2c_f32_bf16 v31, v155, v15
  v_dot2c_f32_bf16 v30, v144, v16
  v_dot2c_f32_bf16 v31, v156, v16
  v_dot2c_f32_bf16 v30, v145, v17
  v_dot2c_f32_bf16 v31, v157, v17
  v_dot2c_f32_bf16 v30, v146, v18
  v_dot2c_f32_bf16 v31, v158, v18
  v_dot2c_f32_bf16 v30, v147, v19
  v_dot2c_f32_bf16 v31, v159, v19
  s_nop 1
  v_add_f32_dpp v30, v30, v30 quad_perm:[1,0,3,2] row_mask:0xf bank_mask:0xf
  v_add_f32_dpp v31, v31, v31 quad_perm:[1,0,3,2] row_mask:0xf bank_mask:0xf
  s_nop 0
  v_add_f32_dpp v30, v30, v30 quad_perm:[2,3,0,1] row_mask:0xf bank_mask:0xf
  v_add_f32_dpp v31, v31, v31 quad_perm:[2,3,0,1] row_mask:0xf bank_mask:0xf
  s_nop 0
  v_add_f32_dpp v30, v30, v30 row_half_mirror row_mask:0xf bank_mask:0xf
  v_add_f32_dpp v31, v31, v31 row_half_mirror row_mask:0xf bank_mask:0xf
  v_cvt_pk_bf16_f32 v56, v30, v31
  v_lshlrev_b32 v30, 16, v56
  v_and_b32 v31, 0xffff0000, v56
  v_mul_f32 v30, 0x3d93cd3a, v30
  v_mul_f32 v31, 0x3d93cd3a, v31
  v_cvt_pk_bf16_f32 v56, v30, v31
  v_lshlrev_b32 v30, 16, v56
  v_and_b32 v31, 0xffff0000, v56
  v_max3_f32 v56, v24, v25, v26
  v_max3_f32 v56, v56, v27, v28
  v_max3_f32 v56, v56, v29, v30
  v_max_f32 v56, v56, v31
  s_nop 1
  v_max_f32_dpp v56, v56, v56 row_ror:8 row_mask:0xf bank_mask:0xf
  v_mov_b32 v57, v56
  s_nop 1
  v_permlane16_swap_b32 v57, v56
  v_max_f32 v56, v57, v56
  v_mov_b32 v57, v56
  s_nop 1
  v_permlane32_swap_b32 v57, v56
  v_max_f32 v56, v57, v56
  s_lshl_b32 s8, s3, 2
  v_mov_b32 v57, s8
  s_mov_b64 exec, 1
  ds_write_b32 v57, v56 offset:512
  s_mov_b64 exec, -1
  s_mov_b32 s8, 0
  buffer_load_dwordx4 v[64:67], v63, s[60:63], s8 offen nt
  s_add_u32 s8, s8, s9
  buffer_load_dwordx4 v[68:71], v63, s[60:63], s8 offen nt
  s_add_u32 s8, s8, s9
  buffer_load_dwordx4 v[72:75], v63, s[60:63], s8 offen nt
  s_mov_b32 s8, s10
  buffer_load_dwordx4 v[76:79], v63, s[64:67], s8 offen nt
  s_add_u32 s8, s8, s9
  buffer_load_dwordx4 v[80:83], v63, s[64:67], s8 offen nt
  s_add_u32 s8, s8, s9
  buffer_load_dwordx4 v[84:87], v63, s[64:67], s8 offen nt
  s_add_u32 s8, s70, 24
  s_and_b32 s8, s8, 63
  s_mul_i32 s8, s8, 3072
  buffer_load_dwordx4 v[196:199], v1, s[48:51], s8 offen offset:0 nt
  buffer_load_dwordx4 v[200:203], v1, s[48:51], s8 offen offset:128 nt
  buffer_load_dwordx4 v[204:207], v1, s[48:51], s8 offen offset:256 nt
  s_add_u32 s8, s70, 32
  s_and_b32 s8, s8, 63
  s_mul_i32 s8, s8, 3072
  buffer_load_dwordx4 v[208:211], v1, s[48:51], s8 offen offset:0 nt
  buffer_load_dwordx4 v[212:215], v1, s[48:51], s8 offen offset:128 nt
  buffer_load_dwordx4 v[216:219], v1, s[48:51], s8 offen offset:256 nt
  s_add_u32 s8, s70, 40
  s_and_b32 s8, s8, 63
  s_mul_i32 s8, s8, 3072
  buffer_load_dwordx4 v[220:223], v1, s[48:51], s8 offen offset:0 nt
  buffer_load_dwordx4 v[224:227], v1, s[48:51], s8 offen offset:128 nt
  buffer_load_dwordx4 v[228:231], v1, s[48:51], s8 offen offset:256 nt
  s_add_u32 s8, s70, 48
  s_and_b32 s8, s8, 63
  s_mul_i32 s8, s8, 3072
  buffer_load_dwordx4 v[232:235], v1, s[48:51], s8 offen offset:0 nt
  buffer_load_dwordx4 v[236:239], v1, s[48:51], s8 offen offset:128 nt
  buffer_load_dwordx4 v[240:243], v1, s[48:51], s8 offen offset:256 nt
  s_add_u32 s8, s70, 56
  s_and_b32 s8, s8, 63
  s_mul_i32 s8, s8, 3072
  buffer_load_dwordx4 v[244:247], v1, s[48:51], s8 offen offset:0 nt
  buffer_load_dwordx4 v[248:251], v1, s[48:51], s8 offen offset:128 nt
  buffer_load_dwordx4 v[252:255], v1, s[48:51], s8 offen offset:256 nt
  v_sub_f32 v24, v24, v56
  v_sub_f32 v25, v25, v56
  v_sub_f32 v26, v26, v56
  v_sub_f32 v27, v27, v56
  v_sub_f32 v28, v28, v56
  v_sub_f32 v29, v29, v56
  v_sub_f32 v30, v30, v56
  v_sub_f32 v31, v31, v56
  v_mul_f32 v24, 0x3fb8aa3b, v24
  v_mul_f32 v25, 0x3fb8aa3b, v25
  v_mul_f32 v26, 0x3fb8aa3b, v26
  v_mul_f32 v27, 0x3fb8aa3b, v27
  v_mul_f32 v28, 0x3fb8aa3b, v28
  v_mul_f32 v29, 0x3fb8aa3b, v29
  v_mul_f32 v30, 0x3fb8aa3b, v30
  v_mul_f32 v31, 0x3fb8aa3b, v31
  v_exp_f32 v24, v24
  v_exp_f32 v25, v25
  v_exp_f32 v26, v26
  v_exp_f32 v27, v27
  v_exp_f32 v28, v28
  v_exp_f32 v29, v29
  v_exp_f32 v30, v30
  v_exp_f32 v31, v31
  v_cvt_pk_bf16_f32 v8, v24, 0
  v_cvt_pk_bf16_f32 v16, 0, v24
  v_cvt_pk_bf16_f32 v9, v25, 0
  v_cvt_pk_bf16_f32 v17, 0, v25
  v_cvt_pk_bf16_f32 v10, v26, 0
  v_cvt_pk_bf16_f32 v18, 0, v26
  v_cvt_pk_bf16_f32 v11, v27, 0
  v_cvt_pk_bf16_f32 v19, 0, v27
  v_cvt_pk_bf16_f32 v12, v28, 0
  v_cvt_pk_bf16_f32 v20, 0, v28
  v_cvt_pk_bf16_f32 v13, v29, 0
  v_cvt_pk_bf16_f32 v21, 0, v29
  v_cvt_pk_bf16_f32 v14, v30, 0
  v_cvt_pk_bf16_f32 v22, 0, v30
  v_cvt_pk_bf16_f32 v15, v31, 0
  v_cvt_pk_bf16_f32 v23, 0, v31
  v_add_f32 v57, v24, v25
  v_add_f32 v57, v57, v26
  v_add_f32 v57, v57, v27
  v_add_f32 v57, v57, v28
  v_add_f32 v57, v57, v29
  v_add_f32 v57, v57, v30
  v_add_f32 v57, v57, v31
  s_nop 1
  v_add_f32_dpp v57, v57, v57 row_ror:8 row_mask:0xf bank_mask:0xf
  v_mov_b32 v62, v57
  s_nop 1
  v_permlane16_swap_b32 v62, v57
  v_add_f32 v57, v62, v57
  v_mov_b32 v62, v57
  s_nop 1
  v_permlane32_swap_b32 v62, v57
  v_add_f32 v57, v62, v57
  s_cmp_lt_u32 s3, 4
  s_cbranch_scc1 L_early1
  s_waitcnt lgkmcnt(0)
  s_barrier
  v_mov_b32 v30, 0
  ds_read_b128 v[24:27], v30 offset:512
  ds_read_b128 v[28:31], v30 offset:528
  s_waitcnt lgkmcnt(0)
  v_max3_f32 v24, v24, v25, v26
  v_max3_f32 v27, v27, v28, v29
  v_max3_f32 v24, v24, v30, v31
  v_max_f32 v24, v24, v27
  v_sub_f32 v31, v56, v24
  v_mul_f32 v31, 0x3fb8aa3b, v31
  v_exp_f32 v31, v31
  v_mov_b32 v56, v24
L_early1:
  v_mov_b32 v32, 0
  v_mov_b32 v33, 0
  v_mov_b32 v34, 0
  v_mov_b32 v35, 0
  v_mov_b32 v36, 0
  v_mov_b32 v37, 0
  v_mov_b32 v38, 0
  v_mov_b32 v39, 0
  v_mov_b32 v40, 0
  v_mov_b32 v41, 0
  v_mov_b32 v42, 0
  v_mov_b32 v43, 0
  v_mov_b32 v44, 0
  v_mov_b32 v45, 0
  v_mov_b32 v46, 0
  v_mov_b32 v47, 0
  v_mov_b32 v48, 0
  v_mov_b32 v49, 0
  v_mov_b32 v50, 0
  v_mov_b32 v51, 0
  v_mov_b32 v52, 0
  v_mov_b32 v53, 0
  v_mov_b32 v54, 0
  v_mov_b32 v55, 0
  s_waitcnt vmcnt(27)
  v_dot2c_f32_bf16 v32, v160, v8
  v_dot2c_f32_bf16 v33, v160, v16
  v_dot2c_f32_bf16 v34, v161, v8
  v_dot2c_f32_bf16 v35, v161, v16
  v_dot2c_f32_bf16 v36, v162, v8
  v_dot2c_f32_bf16 v37, v162, v16
  v_dot2c_f32_bf16 v38, v163, v8
  v_dot2c_f32_bf16 v39, v163, v16
  v_dot2c_f32_bf16 v40, v164, v8
  v_dot2c_f32_bf16 v41, v164, v16
  v_dot2c_f32_bf16 v42, v165, v8
  v_dot2c_f32_bf16 v43, v165, v16
  v_dot2c_f32_bf16 v44, v166, v8
  v_dot2c_f32_bf16 v45, v166, v16
  v_dot2c_f32_bf16 v46, v167, v8
  v_dot2c_f32_bf16 v47, v167, v16
  v_dot2c_f32_bf16 v48, v168, v8
  v_dot2c_f32_bf16 v49, v168, v16
  v_dot2c_f32_bf16 v50, v169, v8
  v_dot2c_f32_bf16 v51, v169, v16
  v_dot2c_f32_bf16 v52, v170, v8
  v_dot2c_f32_bf16 v53, v170, v16
  v_dot2c_f32_bf16 v54, v171, v8
  v_dot2c_f32_bf16 v55, v171, v16
  s_waitcnt vmcnt(24)
  v_dot2c_f32_bf16 v32, v172, v9
  v_dot2c_f32_bf16 v33, v172, v17
  v_dot2c_f32_bf16 v34, v173, v9
  v_dot2c_f32_bf16 v35, v173, v17
  v_dot2c_f32_bf16 v36, v174, v9
  v_dot2c_f32_bf16 v37, v174, v17
  v_dot2c_f32_bf16 v38, v175, v9
  v_dot2c_f32_bf16 v39, v175, v17
  v_dot2c_f32_bf16 v40, v176, v9
  v_dot2c_f32_bf16 v41, v176, v17
  v_dot2c_f32_bf16 v42, v177, v9
  v_dot2c_f32_bf16 v43, v177, v17
  v_dot2c_f32_bf16 v44, v178, v9
  v_dot2c_f32_bf16 v45, v178, v17
  v_dot2c_f32_bf16 v46, v179, v9
  v_dot2c_f32_bf16 v47, v179, v17
  v_dot2c_f32_bf16 v48, v180, v9
  v_dot2c_f32_bf16 v49, v180, v17
  v_dot2c_f32_bf16 v50, v181, v9
  v_dot2c_f32_bf16 v51, v181, v17
  v_dot2c_f32_bf16 v52, v182, v9
  v_dot2c_f32_bf16 v53, v182, v17
  v_dot2c_f32_bf16 v54, v183, v9
  v_dot2c_f32_bf16 v55, v183, v17
  s_waitcnt vmcnt(21)
  v_dot2c_f32_bf16 v32, v184, v10
  v_dot2c_f32_bf16 v33, v184, v18
  v_dot2c_f32_bf16 v34, v185, v10
  v_dot2c_f32_bf16 v35, v185, v18
  v_dot2c_f32_bf16 v36, v186, v10
  v_dot2c_f32_bf16 v37, v186, v18
  v_dot2c_f32_bf16 v38, v187, v10
  v_dot2c_f32_bf16 v39, v187, v18
  v_dot2c_f32_bf16 v40, v188, v10
  v_dot2c_f32_bf16 v41, v188, v18
  v_dot2c_f32_bf16 v42, v189, v10
  v_dot2c_f32_bf16 v43, v189, v18
  v_dot2c_f32_bf16 v44, v190, v10
  v_dot2c_f32_bf16 v45, v190, v18
  v_dot2c_f32_bf16 v46, v191, v10
  v_dot2c_f32_bf16 v47, v191, v18
  v_dot2c_f32_bf16 v48, v192, v10
  v_dot2c_f32_bf16 v49, v192, v18
  v_dot2c_f32_bf16 v50, v193, v10
  v_dot2c_f32_bf16 v51, v193, v18
  v_dot2c_f32_bf16 v52, v194, v10
  v_dot2c_f32_bf16 v53, v194, v18
  v_dot2c_f32_bf16 v54, v195, v10
  v_dot2c_f32_bf16 v55, v195, v18
  s_waitcnt vmcnt(12)
  v_dot2c_f32_bf16 v32, v196, v11
  v_dot2c_f32_bf16 v33, v196, v19
  v_dot2c_f32_bf16 v34, v197, v11
  v_dot2c_f32_bf16 v35, v197, v19
  v_dot2c_f32_bf16 v36, v198, v11
  v_dot2c_f32_bf16 v37, v198, v19
  v_dot2c_f32_bf16 v38, v199, v11
  v_dot2c_f32_bf16 v39, v199, v19
  v_dot2c_f32_bf16 v40, v200, v11
  v_dot2c_f32_bf16 v41, v200, v19
  v_dot2c_f32_bf16 v42, v201, v11
  v_dot2c_f32_bf16 v43, v201, v19
  v_dot2c_f32_bf16 v44, v202, v11
  v_dot2c_f32_bf16 v45, v202, v19
  v_dot2c_f32_bf16 v46, v203, v11
  v_dot2c_f32_bf16 v47, v203, v19
  v_dot2c_f32_bf16 v48, v204, v11
  v_dot2c_f32_bf16 v49, v204, v19
  v_dot2c_f32_bf16 v50, v205, v11
  v_dot2c_f32_bf16 v51, v205, v19
  v_dot2c_f32_bf16 v52, v206, v11
  v_dot2c_f32_bf16 v53, v206, v19
  v_dot2c_f32_bf16 v54, v207, v11
  v_dot2c_f32_bf16 v55, v207, v19
  s_cmp_eq_u32 s3, 5
  s_cbranch_scc0 L_par6
  ds_write_b128 v63, v[64:67] offset:9472
  ds_write_b128 v63, v[68:71] offset:10496
  ds_write_b128 v63, v[72:75] offset:11520
  ds_write_b128 v63, v[76:79] offset:12544
  ds_write_b128 v63, v[80:83] offset:13568
  ds_write_b128 v63, v[84:87] offset:14592
L_par6:
  s_cmp_eq_u32 s3, 6
  s_cbranch_scc0 L_par7
  ds_write_b128 v63, v[64:67] offset:15616
  ds_write_b128 v63, v[68:71] offset:16640
  ds_write_b128 v63, v[72:75] offset:17664
L_par7:
  s_waitcnt vmcnt(9)
  v_dot2c_f32_bf16 v32, v208, v12
  v_dot2c_f32_bf16 v33, v208, v20
  v_dot2c_f32_bf16 v34, v209, v12
  v_dot2c_f32_bf16 v35, v209, v20
  v_dot2c_f32_bf16 v36, v210, v12
  v_dot2c_f32_bf16 v37, v210, v20
  v_dot2c_f32_bf16 v38, v211, v12
  v_dot2c_f32_bf16 v39, v211, v20
  v_dot2c_f32_bf16 v40, v212, v12
  v_dot2c_f32_bf16 v41, v212, v20
  v_dot2c_f32_bf16 v42, v213, v12
  v_dot2c_f32_bf16 v43, v213, v20
  v_dot2c_f32_bf16 v44, v214, v12
  v_dot2c_f32_bf16 v45, v214, v20
  v_dot2c_f32_bf16 v46, v215, v12
  v_dot2c_f32_bf16 v47, v215, v20
  v_dot2c_f32_bf16 v48, v216, v12
  v_dot2c_f32_bf16 v49, v216, v20
  v_dot2c_f32_bf16 v50, v217, v12
  v_dot2c_f32_bf16 v51, v217, v20
  v_dot2c_f32_bf16 v52, v218, v12
  v_dot2c_f32_bf16 v53, v218, v20
  v_dot2c_f32_bf16 v54, v219, v12
  v_dot2c_f32_bf16 v55, v219, v20
  s_waitcnt vmcnt(6)
  v_dot2c_f32_bf16 v32, v220, v13
  v_dot2c_f32_bf16 v33, v220, v21
  v_dot2c_f32_bf16 v34, v221, v13
  v_dot2c_f32_bf16 v35, v221, v21
  v_dot2c_f32_bf16 v36, v222, v13
  v_dot2c_f32_bf16 v37, v222, v21
  v_dot2c_f32_bf16 v38, v223, v13
  v_dot2c_f32_bf16 v39, v223, v21
  v_dot2c_f32_bf16 v40, v224, v13
  v_dot2c_f32_bf16 v41, v224, v21
  v_dot2c_f32_bf16 v42, v225, v13
  v_dot2c_f32_bf16 v43, v225, v21
  v_dot2c_f32_bf16 v44, v226, v13
  v_dot2c_f32_bf16 v45, v226, v21
  v_dot2c_f32_bf16 v46, v227, v13
  v_dot2c_f32_bf16 v47, v227, v21
  v_dot2c_f32_bf16 v48, v228, v13
  v_dot2c_f32_bf16 v49, v228, v21
  v_dot2c_f32_bf16 v50, v229, v13
  v_dot2c_f32_bf16 v51, v229, v21
  v_dot2c_f32_bf16 v52, v230, v13
  v_dot2c_f32_bf16 v53, v230, v21
  v_dot2c_f32_bf16 v54, v231, v13
  v_dot2c_f32_bf16 v55, v231, v21
  s_waitcnt vmcnt(3)
  v_dot2c_f32_bf16 v32, v232, v14
  v_dot2c_f32_bf16 v33, v232, v22
  v_dot2c_f32_bf16 v34, v233, v14
  v_dot2c_f32_bf16 v35, v233, v22
  v_dot2c_f32_bf16 v36, v234, v14
  v_dot2c_f32_bf16 v37, v234, v22
  v_dot2c_f32_bf16 v38, v235, v14
  v_dot2c_f32_bf16 v39, v235, v22
  v_dot2c_f32_bf16 v40, v236, v14
  v_dot2c_f32_bf16 v41, v236, v22
  v_dot2c_f32_bf16 v42, v237, v14
  v_dot2c_f32_bf16 v43, v237, v22
  v_dot2c_f32_bf16 v44, v238, v14
  v_dot2c_f32_bf16 v45, v238, v22
  v_dot2c_f32_bf16 v46, v239, v14
  v_dot2c_f32_bf16 v47, v239, v22
  v_dot2c_f32_bf16 v48, v240, v14
  v_dot2c_f32_bf16 v49, v240, v22
  v_dot2c_f32_bf16 v50, v241, v14
  v_dot2c_f32_bf16 v51, v241, v22
  v_dot2c_f32_bf16 v52, v242, v14
  v_dot2c_f32_bf16 v53, v242, v22
  v_dot2c_f32_bf16 v54, v243, v14
  v_dot2c_f32_bf16 v55, v243, v22
  s_waitcnt vmcnt(0)
  v_dot2c_f32_bf16 v32, v244, v15
  v_dot2c_f32_bf16 v33, v244, v23
  v_dot2c_f32_bf16 v34, v245, v15
  v_dot2c_f32_bf16 v35, v245, v23
  v_dot2c_f32_bf16 v36, v246, v15
  v_dot2c_f32_bf16 v37, v246, v23
  v_dot2c_f32_bf16 v38, v247, v15
  v_dot2c_f32_bf16 v39, v247, v23
  v_dot2c_f32_bf16 v40, v248, v15
  v_dot2c_f32_bf16 v41, v248, v23
  v_dot2c_f32_bf16 v42, v249, v15
  v_dot2c_f32_bf16 v43, v249, v23
  v_dot2c_f32_bf16 v44, v250, v15
  v_dot2c_f32_bf16 v45, v250, v23
  v_dot2c_f32_bf16 v46, v251, v15
  v_dot2c_f32_bf16 v47, v251, v23
  v_dot2c_f32_bf16 v48, v252, v15
  v_dot2c_f32_bf16 v49, v252, v23
  v_dot2c_f32_bf16 v50, v253, v15
  v_dot2c_f32_bf16 v51, v253, v23
  v_dot2c_f32_bf16 v52, v254, v15
  v_dot2c_f32_bf16 v53, v254, v23
  v_dot2c_f32_bf16 v54, v255, v15
  v_dot2c_f32_bf16 v55, v255, v23
  v_permlane32_swap_b32 v32, v36
  v_permlane32_swap_b32 v33, v37
  v_permlane32_swap_b32 v34, v38
  v_permlane32_swap_b32 v35, v39
  v_permlane32_swap_b32 v40, v44
  v_permlane32_swap_b32 v41, v45
  v_permlane32_swap_b32 v42, v46
  v_permlane32_swap_b32 v43, v47
  v_permlane32_swap_b32 v48, v52
  v_permlane32_swap_b32 v49, v53
  v_permlane32_swap_b32 v50, v54
  v_permlane32_swap_b32 v51, v55
  v_add_f32 v32, v32, v36
  v_add_f32 v33, v33, v37
  v_add_f32 v34, v34, v38
  v_add_f32 v35, v35, v39
  v_add_f32 v40, v40, v44
  v_add_f32 v41, v41, v45
  v_add_f32 v42, v42, v46
  v_add_f32 v43, v43, v47
  v_add_f32 v48, v48, v52
  v_add_f32 v49, v49, v53
  v_add_f32 v50, v50, v54
  v_add_f32 v51, v51, v55
  v_permlane16_swap_b32 v32, v34
  v_permlane16_swap_b32 v33, v35
  v_permlane16_swap_b32 v40, v42
  v_permlane16_swap_b32 v41, v43
  v_permlane16_swap_b32 v48, v50
  v_permlane16_swap_b32 v49, v51
  v_add_f32 v32, v32, v34
  v_add_f32 v33, v33, v35
  v_add_f32 v40, v40, v42
  v_add_f32 v41, v41, v43
  v_add_f32 v48, v48, v50
  v_add_f32 v49, v49, v51
  v_add_f32_dpp v32, v32, v32 row_ror:8 row_mask:0xf bank_mask:0xf
  v_add_f32_dpp v33, v33, v33 row_ror:8 row_mask:0xf bank_mask:0xf
  v_add_f32_dpp v40, v40, v40 row_ror:8 row_mask:0xf bank_mask:0xf
  v_add_f32_dpp v41, v41, v41 row_ror:8 row_mask:0xf bank_mask:0xf
  v_add_f32_dpp v48, v48, v48 row_ror:8 row_mask:0xf bank_mask:0xf
  v_add_f32_dpp v49, v49, v49 row_ror:8 row_mask:0xf bank_mask:0xf
  s_cmp_lt_u32 s3, 4
  s_cbranch_scc0 L_late2
  s_waitcnt lgkmcnt(0)
  s_barrier
  s_mov_b32 s62, 60288
  s_mov_b32 s8, 0
  buffer_load_dwordx4 v[64:67], v7, s[60:63], s8 offen nt
  s_mov_b32 s8, 10240
  buffer_load_dwordx4 v[68:71], v7, s[60:63], s8 offen nt
  s_mov_b32 s8, 20480
  buffer_load_dwordx4 v[72:75], v7, s[60:63], s8 offen nt
  s_mov_b32 s8, 30720
  buffer_load_dwordx4 v[76:79], v7, s[60:63], s8 offen nt
  s_mov_b32 s8, 40960
  buffer_load_dwordx4 v[80:83], v7, s[60:63], s8 offen nt
  s_mov_b32 s8, 51200
  buffer_load_dwordx4 v[84:87], v7, s[60:63], s8 offen nt
  v_mov_b32 v30, 0
  ds_read_b128 v[24:27], v30 offset:512
  ds_read_b128 v[28:31], v30 offset:528
  s_waitcnt lgkmcnt(0)
  v_max3_f32 v24, v24, v25, v26
  v_max3_f32 v27, v27, v28, v29
  v_max3_f32 v24, v24, v30, v31
  v_max_f32 v24, v24, v27
  v_sub_f32 v31, v56, v24
  v_mul_f32 v31, 0x3fb8aa3b, v31
  v_exp_f32 v31, v31
  v_mov_b32 v56, v24
L_late2:
L_pre2:
  v_mul_f32 v32, v32, v31
  v_mul_f32 v33, v33, v31
  v_mul_f32 v40, v40, v31
  v_mul_f32 v41, v41, v31
  v_mul_f32 v48, v48, v31
  v_mul_f32 v49, v49, v31
  v_mul_f32 v57, v57, v31
  ds_write_b32 v58, v32 offset:1024
  ds_write_b32 v58, v33 offset:1056
  ds_write_b32 v59, v40 offset:1024
  ds_write_b32 v59, v41 offset:1056
  ds_write_b32 v60, v48 offset:1024
  ds_write_b32 v60, v49 offset:1056
  s_mov_b32 exec_hi, 0
  ds_write_b32 v61, v57 offset:1052
  s_mov_b32 exec_hi, -1
  v_mov_b32 v52, s80
  s_waitcnt lgkmcnt(0)
  s_barrier
  s_cmp_eq_u32 s3, 5
  s_cbranch_scc0 L_notpub
  s_setprio 3
  v_lshlrev_b32 v5, 4, v0
  ds_read_b128 v[8:11], v5 offset:1024
  ds_read_b128 v[12:15], v5 offset:2048
  ds_read_b128 v[16:19], v5 offset:3072
  ds_read_b128 v[20:23], v5 offset:4096
  ds_read_b128 v[24:27], v5 offset:5120
  ds_read_b128 v[28:31], v5 offset:6144
  ds_read_b128 v[32:35], v5 offset:7168
  ds_read_b128 v[36:39], v5 offset:8192
  v_and_b32 v6, 1, v0
  v_cmp_eq_u32 vcc, 1, v6
  s_lshl_b32 s8, s6, 10
  s_add_u32 s8, s8, 327680
  s_waitcnt lgkmcnt(6)
  v_pk_add_f32 v[8:9], v[8:9], v[12:13]
  v_pk_add_f32 v[10:11], v[10:11], v[14:15]
  s_waitcnt lgkmcnt(4)
  v_pk_add_f32 v[16:17], v[16:17], v[20:21]
  v_pk_add_f32 v[18:19], v[18:19], v[22:23]
  v_pk_add_f32 v[8:9], v[8:9], v[16:17]
  v_pk_add_f32 v[10:11], v[10:11], v[18:19]
  s_waitcnt lgkmcnt(2)
  v_pk_add_f32 v[24:25], v[24:25], v[28:29]
  v_pk_add_f32 v[26:27], v[26:27], v[30:31]
  s_waitcnt lgkmcnt(0)
  v_pk_add_f32 v[32:33], v[32:33], v[36:37]
  v_pk_add_f32 v[34:35], v[34:35], v[38:39]
  v_pk_add_f32 v[24:25], v[24:25], v[32:33]
  v_pk_add_f32 v[26:27], v[26:27], v[34:35]
  v_pk_add_f32 v[8:9], v[8:9], v[24:25]
  v_pk_add_f32 v[10:11], v[10:11], v[26:27]
  v_cndmask_b32 v10, v10, v56, vcc
  v_perm_b32 v8, v8, v52, s72
  v_perm_b32 v9, v9, v52, s73
  v_perm_b32 v10, v10, v52, s74
  v_perm_b32 v11, v11, v52, s75
  s_cmp_eq_u32 s81, 1
  s_cbranch_scc1 L_pub_fast
  buffer_store_dwordx4 v[8:11], v5, s[52:55], s8 offen sc1
  s_branch L_pub_done
L_pub_fast:
  buffer_store_dwordx4 v[8:11], v5, s[52:55], s8 offen
L_pub_done:
  s_branch L_done
L_notpub:
  s_cmp_gt_u32 s3, 4
  s_cbranch_scc1 L_done
  s_mul_i32 s11, s43, 80
  s_lshl_b32 s12, s3, 4
  s_add_u32 s11, s11, s12
  s_lshl_b32 s11, s11, 11
  s_lshl_b32 s12, s4, 2
  s_add_u32 s12, s12, s42
  s_lshl_b32 s12, s12, 4
  s_add_u32 s11, s11, s12
  s_add_u32 s11, s11, 655360
  v_bfe_u32 v53, v0, 1, 2
  v_lshrrev_b32 v54, 4, v0
  v_lshl_add_u32 v53, v54, 2, v53
  v_lshlrev_b32 v53, 11, v53
  v_mov_b32 v32, 0
  v_mov_b32 v33, 0
  v_mov_b32 v34, 0
  v_mov_b32 v35, 0
  v_mov_b32 v36, 0
  v_mov_b32 v37, 0
  v_mov_b32 v38, 0
  v_mov_b32 v39, 0
  v_lshlrev_b32 v6, 5, v2
  s_cmp_eq_u32 s3, 0
  s_cbranch_scc0 L_owait
  v_lshlrev_b32 v5, 10, v3
  v_lshl_add_u32 v5, v2, 5, v5
  s_lshl_b32 s8, s4, 13
  s_lshl_b32 s12, s42, 8
  s_add_u32 s8, s8, s12
  s_add_u32 s8, s8, 327680
  buffer_load_dwordx4 v[196:199], v5, s[52:55], s8 offen sc1
  buffer_load_dwordx4 v[200:203], v5, s[52:55], s8 offen offset:16 sc1
L_opoll_loop:
  s_waitcnt vmcnt(0)
  v_perm_b32 v7, v197, v196, s76
  v_perm_b32 v9, v199, v198, s77
  v_or_b32 v7, v7, v9
  v_cmp_eq_u32 s[12:13], s80, v7
  v_perm_b32 v7, v201, v200, s76
  v_perm_b32 v9, v203, v202, s77
  v_or_b32 v7, v7, v9
  v_cmp_eq_u32 vcc, s80, v7
  s_and_b64 s[12:13], s[12:13], vcc
  s_cmp_eq_u64 s[12:13], exec
  s_cbranch_scc1 L_opoll_ok0
  s_sub_u32 s78, s78, 1
  s_cmp_eq_u32 s78, 0
  s_cbranch_scc1 L_opoll_ok0
  buffer_load_dwordx4 v[196:199], v5, s[52:55], s8 offen sc1
  buffer_load_dwordx4 v[200:203], v5, s[52:55], s8 offen offset:16 sc1
  s_branch L_opoll_loop
L_opoll_ok0:
  v_and_b32 v8, 0xffffff00, v196
  v_and_b32 v9, 0xffffff00, v197
  v_and_b32 v10, 0xffffff00, v198
  v_and_b32 v11, 0xffffff00, v199
  v_and_b32 v12, 0xffffff00, v200
  v_and_b32 v13, 0xffffff00, v201
  v_and_b32 v14, 0xffffff00, v202
  v_and_b32 v15, 0xffffff00, v203
L_opoll_done:
  s_nop 0
  v_max_f32_dpp v16, v14, v14 quad_perm:[1,0,3,2] row_mask:0xf bank_mask:0xf
  s_nop 1
  v_max_f32_dpp v16, v16, v16 quad_perm:[2,3,0,1] row_mask:0xf bank_mask:0xf
  s_nop 1
  v_max_f32_dpp v16, v16, v16 row_half_mirror row_mask:0xf bank_mask:0xf
  v_sub_f32 v14, v14, v16
  v_mul_f32 v14, 0x3fb8aa3b, v14
  v_exp_f32 v14, v14
  s_nop 0
  v_mul_f32 v15, v15, v14
  v_pk_mul_f32 v[8:9], v[8:9], v[14:15] op_sel_hi:[1,0]
  v_pk_mul_f32 v[10:11], v[10:11], v[14:15] op_sel_hi:[1,0]
  v_pk_mul_f32 v[12:13], v[12:13], v[14:15] op_sel_hi:[1,0]
  v_add_f32_dpp v15, v15, v15 quad_perm:[1,0,3,2] row_mask:0xf bank_mask:0xf
  v_add_f32_dpp v8, v8, v8 quad_perm:[1,0,3,2] row_mask:0xf bank_mask:0xf
  v_add_f32_dpp v9, v9, v9 quad_perm:[1,0,3,2] row_mask:0xf bank_mask:0xf
  v_add_f32_dpp v10, v10, v10 quad_perm:[1,0,3,2] row_mask:0xf bank_mask:0xf
  v_add_f32_dpp v11, v11, v11 quad_perm:[1,0,3,2] row_mask:0xf bank_mask:0xf
  v_add_f32_dpp v12, v12, v12 quad_perm:[1,0,3,2] row_mask:0xf bank_mask:0xf
  v_add_f32_dpp v13, v13, v13 quad_perm:[1,0,3,2] row_mask:0xf bank_mask:0xf
  v_add_f32_dpp v15, v15, v15 quad_perm:[2,3,0,1] row_mask:0xf bank_mask:0xf
  v_add_f32_dpp v8, v8, v8 quad_perm:[2,3,0,1] row_mask:0xf bank_mask:0xf
  v_add_f32_dpp v9, v9, v9 quad_perm:[2,3,0,1] row_mask:0xf bank_mask:0xf
  v_add_f32_dpp v10, v10, v10 quad_perm:[2,3,0,1] row_mask:0xf bank_mask:0xf
  v_add_f32_dpp v11, v11, v11 quad_perm:[2,3,0,1] row_mask:0xf bank_mask:0xf
  v_add_f32_dpp v12, v12, v12 quad_perm:[2,3,0,1] row_mask:0xf bank_mask:0xf
  v_add_f32_dpp v13, v13, v13 quad_perm:[2,3,0,1] row_mask:0xf bank_mask:0xf
  v_add_f32_dpp v15, v15, v15 row_half_mirror row_mask:0xf bank_mask:0xf
  v_add_f32_dpp v8, v8, v8 row_half_mirror row_mask:0xf bank_mask:0xf
  v_add_f32_dpp v9, v9, v9 row_half_mirror row_mask:0xf bank_mask:0xf
  v_add_f32_dpp v10, v10, v10 row_half_mirror row_mask:0xf bank_mask:0xf
  v_add_f32_dpp v11, v11, v11 row_half_mirror row_mask:0xf bank_mask:0xf
  v_add_f32_dpp v12, v12, v12 row_half_mirror row_mask:0xf bank_mask:0xf
  v_add_f32_dpp v13, v13, v13 row_half_mirror row_mask:0xf bank_mask:0xf
  v_rcp_f32 v14, v15
  s_nop 0
  v_pk_mul_f32 v[8:9], v[8:9], v[14:15] op_sel_hi:[1,0]
  v_pk_mul_f32 v[10:11], v[10:11], v[14:15] op_sel_hi:[1,0]
  v_pk_mul_f32 v[12:13], v[12:13], v[14:15] op_sel_hi:[1,0]
  v_cvt_pk_bf16_f32 v8, v8, 0
  v_cvt_pk_bf16_f32 v9, v9, 0
  v_cvt_pk_bf16_f32 v10, v10, 0
  v_cvt_pk_bf16_f32 v11, v11, 0
  v_cvt_pk_bf16_f32 v12, v12, 0
  v_cvt_pk_bf16_f32 v13, v13, 0
  s_mov_b32 exec_lo, 0x01010101
  s_mov_b32 exec_hi, 0x01010101
  ds_write_b128 v6, v[8:11] offset:18688
  ds_write_b64 v6, v[12:13] offset:18704
  s_mov_b64 exec, -1
  s_waitcnt lgkmcnt(0)
L_owait:
  s_barrier
  ds_read_b128 v[8:11], v6 offset:18688
  ds_read_b64 v[12:13], v6 offset:18704
  s_cmp_eq_u32 s3, 0
  s_cbranch_scc1 L_ow0
  s_waitcnt vmcnt(0)
L_ow0:
  s_waitcnt lgkmcnt(0)
  v_lshlrev_b32 v16, 16, v8
  v_lshlrev_b32 v17, 16, v9
  v_lshlrev_b32 v18, 16, v10
  v_lshlrev_b32 v19, 16, v11
  v_lshlrev_b32 v20, 16, v12
  v_lshlrev_b32 v21, 16, v13
  v_dot2c_f32_bf16 v32, v64, v8
  v_dot2c_f32_bf16 v33, v64, v16
  v_dot2c_f32_bf16 v34, v65, v8
  v_dot2c_f32_bf16 v35, v65, v16
  v_dot2c_f32_bf16 v36, v66, v8
  v_dot2c_f32_bf16 v37, v66, v16
  v_dot2c_f32_bf16 v38, v67, v8
  v_dot2c_f32_bf16 v39, v67, v16
  v_dot2c_f32_bf16 v32, v68, v9
  v_dot2c_f32_bf16 v33, v68, v17
  v_dot2c_f32_bf16 v34, v69, v9
  v_dot2c_f32_bf16 v35, v69, v17
  v_dot2c_f32_bf16 v36, v70, v9
  v_dot2c_f32_bf16 v37, v70, v17
  v_dot2c_f32_bf16 v38, v71, v9
  v_dot2c_f32_bf16 v39, v71, v17
  v_dot2c_f32_bf16 v32, v72, v10
  v_dot2c_f32_bf16 v33, v72, v18
  v_dot2c_f32_bf16 v34, v73, v10
  v_dot2c_f32_bf16 v35, v73, v18
  v_dot2c_f32_bf16 v36, v74, v10
  v_dot2c_f32_bf16 v37, v74, v18
  v_dot2c_f32_bf16 v38, v75, v10
  v_dot2c_f32_bf16 v39, v75, v18
  v_dot2c_f32_bf16 v32, v76, v11
  v_dot2c_f32_bf16 v33, v76, v19
  v_dot2c_f32_bf16 v34, v77, v11
  v_dot2c_f32_bf16 v35, v77, v19
  v_dot2c_f32_bf16 v36, v78, v11
  v_dot2c_f32_bf16 v37, v78, v19
  v_dot2c_f32_bf16 v38, v79, v11
  v_dot2c_f32_bf16 v39, v79, v19
  v_dot2c_f32_bf16 v32, v80, v12
  v_dot2c_f32_bf16 v33, v80, v20
  v_dot2c_f32_bf16 v34, v81, v12
  v_dot2c_f32_bf16 v35, v81, v20
  v_dot2c_f32_bf16 v36, v82, v12
  v_dot2c_f32_bf16 v37, v82, v20
  v_dot2c_f32_bf16 v38, v83, v12
  v_dot2c_f32_bf16 v39, v83, v20
  v_dot2c_f32_bf16 v32, v84, v13
  v_dot2c_f32_bf16 v33, v84, v21
  v_dot2c_f32_bf16 v34, v85, v13
  v_dot2c_f32_bf16 v35, v85, v21
  v_dot2c_f32_bf16 v36, v86, v13
  v_dot2c_f32_bf16 v37, v86, v21
  v_dot2c_f32_bf16 v38, v87, v13
  v_dot2c_f32_bf16 v39, v87, v21
  v_permlane32_swap_b32 v32, v36
  v_permlane32_swap_b32 v33, v37
  v_permlane32_swap_b32 v34, v38
  v_permlane32_swap_b32 v35, v39
  v_add_f32 v32, v32, v36
  v_add_f32 v33, v33, v37
  v_add_f32 v34, v34, v38
  v_add_f32 v35, v35, v39
  s_nop 0
  v_permlane16_swap_b32 v32, v34
  v_permlane16_swap_b32 v33, v35
  v_add_f32 v32, v32, v34
  v_add_f32 v33, v33, v35
  s_nop 0
  v_add_f32_dpp v32, v32, v32 row_ror:8 row_mask:0xf bank_mask:0xf
  v_add_f32_dpp v33, v33, v33 row_ror:8 row_mask:0xf bank_mask:0xf
  s_nop 0
  v_mov_b32_dpp v34, v32 quad_perm:[1,1,3,3] row_mask:0xf bank_mask:0xf
  v_mov_b32_dpp v35, v33 quad_perm:[1,1,3,3] row_mask:0xf bank_mask:0xf
  v_perm_b32 v32, v32, v52, s72
  v_perm_b32 v33, v33, v52, s73
  v_perm_b32 v34, v34, v52, s74
  v_perm_b32 v35, v35, v52, s75
  s_mov_b32 exec_lo, 0x00550055
  s_mov_b32 exec_hi, 0x00550055
  buffer_store_dwordx4 v[32:35], v53, s[52:55], s11 offen sc1
  s_mov_b64 exec, -1
  s_cmp_eq_u32 s3, 4
  s_cbranch_scc1 L_done
  s_cmp_eq_u32 s39, 0
  s_cbranch_scc1 L_done
  s_cmp_eq_u32 s3, 0
  s_cbranch_scc0 L_prep123
L_reducer:
  v_lshlrev_b32 v5, 4, v0
  s_lshl_b32 s8, s38, 11
  s_add_u32 s8, s8, 655360
  v_mov_b32 v12, s100
  v_mov_b32 v13, s101
  v_lshrrev_b32 v6, 4, v0
  v_and_b32 v7, 1, v6
  v_cmp_eq_u32 vcc, 1, v7
  s_nop 1
  v_cndmask_b32 v12, v12, v13, vcc
  v_lshlrev_b32 v13, 16, v12
  v_and_b32 v12, 0xffff0000, v12
  v_cmp_le_u32 vcc, 2, v6
  s_nop 1
  v_cndmask_b32 v12, v13, v12, vcc
  v_lshlrev_b32 v24, 12, v0
  s_lshl_b32 s11, s38, 4
  s_add_u32 s11, s11, 1048576
  s_and_b32 s15, s2, 7
  s_lshl_b32 s15, s15, 12
  s_add_u32 s15, s15, 1048576
  v_mov_b32 v20, 0
  v_mov_b32 v21, 0
  v_mov_b32 v22, 0x3f803f80
  v_mov_b32 v30, s80
  v_mov_b32 v31, s80
  s_waitcnt vmcnt(0)
  buffer_load_dwordx4 v[196:199], v5, s[52:55], s8 offen sc1
  buffer_load_dwordx4 v[200:203], v5, s[52:55], s8 offen offset:1024 sc1
L_rpoll_loop:
  s_waitcnt vmcnt(0)
  v_perm_b32 v7, v197, v196, s76
  v_perm_b32 v9, v199, v198, s77
  v_or_b32 v7, v7, v9
  v_cmp_eq_u32 s[12:13], s80, v7
  v_perm_b32 v7, v201, v200, s76
  v_perm_b32 v9, v203, v202, s77
  v_or_b32 v7, v7, v9
  v_cmp_eq_u32 vcc, s80, v7
  s_and_b64 s[12:13], s[12:13], vcc
  s_cmp_eq_u64 s[12:13], exec
  s_cbranch_scc1 L_rpoll_ok0
  s_sub_u32 s78, s78, 1
  s_cmp_eq_u32 s78, 0
  s_cbranch_scc1 L_rpoll_ok0
  buffer_load_dwordx4 v[196:199], v5, s[52:55], s8 offen sc1
  buffer_load_dwordx4 v[200:203], v5, s[52:55], s8 offen offset:1024 sc1
  s_branch L_rpoll_loop
L_rpoll_ok0:
  v_and_b32 v8, 0xffffff00, v196
  v_and_b32 v9, 0xffffff00, v197
  v_and_b32 v10, 0xffffff00, v198
  v_and_b32 v11, 0xffffff00, v199
  v_and_b32 v16, 0xffffff00, v200
  v_and_b32 v17, 0xffffff00, v201
  v_and_b32 v18, 0xffffff00, v202
  v_and_b32 v19, 0xffffff00, v203
L_rpoll_done:
  v_pk_add_f32 v[8:9], v[8:9], v[16:17]
  v_pk_add_f32 v[10:11], v[10:11], v[18:19]
  s_nop 0
  v_permlane32_swap_b32 v8, v9
  v_permlane32_swap_b32 v10, v11
  v_add_f32 v8, v8, v9
  v_add_f32 v10, v10, v11
  s_nop 1
  v_permlane16_swap_b32 v8, v10
  v_add_f32 v8, v8, v10
  s_nop 1
  v_add_f32_dpp v8, v8, v8 quad_perm:[1,0,3,2] row_mask:0xf bank_mask:0xf
  s_nop 1
  v_add_f32_dpp v8, v8, v8 quad_perm:[2,3,0,1] row_mask:0xf bank_mask:0xf
  s_nop 1
  v_add_f32_dpp v8, v8, v8 row_half_mirror row_mask:0xf bank_mask:0xf
  s_nop 1
  v_add_f32_dpp v8, v8, v8 row_mirror row_mask:0xf bank_mask:0xf
  v_cvt_pk_bf16_f32 v8, v8, v8
  v_and_b32 v8, 0xffff0000, v8
  v_add_f32 v8, v8, v12
  v_cvt_pk_bf16_f32 v8, v8, v8
  s_nop 0
  v_readlane_b32 s8, v8, 0
  v_readlane_b32 s9, v8, 32
  v_readlane_b32 s10, v8, 16
  v_readlane_b32 s12, v8, 48
  s_pack_ll_b32_b16 s8, s8, s9
  s_pack_ll_b32_b16 s10, s10, s12
  v_mov_b32 v28, s8
  v_mov_b32 v29, s10
  s_mov_b64 exec, 0xff
  buffer_store_dwordx4 v[28:31], v24, s[52:55], s11 offen sc1
  s_mov_b64 exec, -1
  v_lshlrev_b32 v24, 16, v28
  v_and_b32 v25, 0xffff0000, v28
  v_lshlrev_b32 v26, 16, v29
  v_and_b32 v27, 0xffff0000, v29
  v_mov_b32 v23, 0
  s_mov_b64 exec, 1
  ds_write_b128 v23, v[24:27] offset:9232
  s_mov_b64 exec, -1
  s_mov_b32 s64, s34
  s_mov_b32 s65, s35
  s_mov_b32 s66, 2
  s_mov_b32 s67, 0x20000
  buffer_load_ushort v57, off, s[64:67], 0
  v_lshlrev_b32 v56, 4, v0
  ds_read_b128 v[160:163], v56 offset:9472
  ds_read_b128 v[164:167], v56 offset:10496
  ds_read_b128 v[168:171], v56 offset:11520
  ds_read_b128 v[172:175], v56 offset:12544
  ds_read_b128 v[176:179], v56 offset:13568
  ds_read_b128 v[180:183], v56 offset:14592
  ds_read_b128 v[184:187], v56 offset:15616
  ds_read_b128 v[188:191], v56 offset:16640
  ds_read_b128 v[192:195], v56 offset:17664
  s_mov_b32 s70, 0xbdd2d3e8
  s_mov_b32 s71, 0xbdd2d3e8
  v_mov_b32 v62, 0xc0135761
  v_mov_b32 v63, 0xc0135761
  s_lshl_b32 s8, s3, 2
  v_mov_b32 v4, s8
  s_and_b32 s8, s3, 1
  s_lshl_b32 s8, s8, 1
  s_lshr_b32 s9, s3, 1
  s_lshl_b32 s9, s9, 4
  s_add_u32 s8, s8, s9
  s_add_u32 s14, s8, s68
  s_mov_b32 s64, s36
  s_mov_b32 s65, s37
  s_mov_b32 s66, 1280
  s_mov_b32 s67, 0x20000
  v_mov_b32 v58, 0
  v_mov_b32 v59, 0
  s_waitcnt lgkmcnt(6)
  v_lshlrev_b32 v64, 16, v160
  v_and_b32 v65, 0xffff0000, v160
  v_lshlrev_b32 v66, 16, v161
  v_and_b32 v67, 0xffff0000, v161
  v_lshlrev_b32 v68, 16, v162
  v_and_b32 v69, 0xffff0000, v162
  v_lshlrev_b32 v70, 16, v163
  v_and_b32 v71, 0xffff0000, v163
  v_lshlrev_b32 v72, 16, v164
  v_and_b32 v73, 0xffff0000, v164
  v_lshlrev_b32 v74, 16, v165
  v_and_b32 v75, 0xffff0000, v165
  v_lshlrev_b32 v76, 16, v166
  v_and_b32 v77, 0xffff0000, v166
  v_lshlrev_b32 v78, 16, v167
  v_and_b32 v79, 0xffff0000, v167
  v_lshlrev_b32 v80, 16, v168
  v_and_b32 v81, 0xffff0000, v168
  v_lshlrev_b32 v82, 16, v169
  v_and_b32 v83, 0xffff0000, v169
  v_lshlrev_b32 v84, 16, v170
  v_and_b32 v85, 0xffff0000, v170
  v_lshlrev_b32 v86, 16, v171
  v_and_b32 v87, 0xffff0000, v171
  s_waitcnt lgkmcnt(3)
  v_lshlrev_b32 v88, 16, v172
  v_and_b32 v89, 0xffff0000, v172
  v_lshlrev_b32 v90, 16, v173
  v_and_b32 v91, 0xffff0000, v173
  v_lshlrev_b32 v92, 16, v174
  v_and_b32 v93, 0xffff0000, v174
  v_lshlrev_b32 v94, 16, v175
  v_and_b32 v95, 0xffff0000, v175
  v_lshlrev_b32 v96, 16, v176
  v_and_b32 v97, 0xffff0000, v176
  v_lshlrev_b32 v98, 16, v177
  v_and_b32 v99, 0xffff0000, v177
  v_lshlrev_b32 v100, 16, v178
  v_and_b32 v101, 0xffff0000, v178
  v_lshlrev_b32 v102, 16, v179
  v_and_b32 v103, 0xffff0000, v179
  v_lshlrev_b32 v104, 16, v180
  v_and_b32 v105, 0xffff0000, v180
  v_lshlrev_b32 v106, 16, v181
  v_and_b32 v107, 0xffff0000, v181
  v_lshlrev_b32 v108, 16, v182
  v_and_b32 v109, 0xffff0000, v182
  v_lshlrev_b32 v110, 16, v183
  v_and_b32 v111, 0xffff0000, v183
  s_waitcnt lgkmcnt(0)
  v_lshlrev_b32 v112, 16, v184
  v_and_b32 v113, 0xffff0000, v184
  v_lshlrev_b32 v114, 16, v185
  v_and_b32 v115, 0xffff0000, v185
  v_lshlrev_b32 v116, 16, v186
  v_and_b32 v117, 0xffff0000, v186
  v_lshlrev_b32 v118, 16, v187
  v_and_b32 v119, 0xffff0000, v187
  v_lshlrev_b32 v120, 16, v188
  v_and_b32 v121, 0xffff0000, v188
  v_lshlrev_b32 v122, 16, v189
  v_and_b32 v123, 0xffff0000, v189
  v_lshlrev_b32 v124, 16, v190
  v_and_b32 v125, 0xffff0000, v190
  v_lshlrev_b32 v126, 16, v191
  v_and_b32 v127, 0xffff0000, v191
  v_lshlrev_b32 v128, 16, v192
  v_and_b32 v129, 0xffff0000, v192
  v_lshlrev_b32 v130, 16, v193
  v_and_b32 v131, 0xffff0000, v193
  v_lshlrev_b32 v132, 16, v194
  v_and_b32 v133, 0xffff0000, v194
  v_lshlrev_b32 v134, 16, v195
  v_and_b32 v135, 0xffff0000, v195
  s_waitcnt vmcnt(0) lgkmcnt(0)
  v_lshlrev_b32 v57, 16, v57
  buffer_load_dwordx4 v[220:223], v5, s[52:55], s15 offen sc1
  buffer_load_dwordx4 v[224:227], v5, s[52:55], s15 offen offset:1024 sc1
  s_mov_b32 exec_hi, 0
  buffer_load_dwordx4 v[228:231], v5, s[52:55], s15 offen offset:2048 sc1
  s_mov_b32 exec_hi, -1
L_hpoll_loop:
  s_waitcnt vmcnt(0)
  v_cmp_eq_u32 s[12:13], s80, v222
  v_cmp_eq_u32 vcc, s80, v226
  s_and_b64 s[12:13], s[12:13], vcc
  v_cmp_eq_u32 vcc, s80, v230
  s_or_b32 vcc_hi, vcc_hi, -1
  s_and_b64 s[12:13], s[12:13], vcc
  s_cmp_eq_u64 s[12:13], exec
  s_cbranch_scc1 L_hpoll_ok0
  s_sub_u32 s78, s78, 1
  s_cmp_eq_u32 s78, 0
  s_cbranch_scc1 L_hpoll_ok0
  buffer_load_dwordx4 v[220:223], v5, s[52:55], s15 offen sc1
  buffer_load_dwordx4 v[224:227], v5, s[52:55], s15 offen offset:1024 sc1
  s_mov_b32 exec_hi, 0
  buffer_load_dwordx4 v[228:231], v5, s[52:55], s15 offen offset:2048 sc1
  s_mov_b32 exec_hi, -1
  s_branch L_hpoll_loop
L_hpoll_ok0:
  v_mov_b32 v16, 0
  v_mov_b32 v17, 0
  v_mov_b32 v8, v220
  v_mov_b32 v9, v221
  v_mov_b32 v12, v224
  v_mov_b32 v13, v225
  s_mov_b32 exec_hi, 0
  v_mov_b32 v16, v228
  v_mov_b32 v17, v229
  s_mov_b32 exec_hi, -1
L_hpoll_done:
  v_dot2c_f32_bf16 v20, v8, v22
  v_dot2c_f32_bf16 v21, v8, v8
  v_dot2c_f32_bf16 v20, v9, v22
  v_dot2c_f32_bf16 v21, v9, v9
  v_dot2c_f32_bf16 v20, v12, v22
  v_dot2c_f32_bf16 v21, v12, v12
  v_dot2c_f32_bf16 v20, v13, v22
  v_dot2c_f32_bf16 v21, v13, v13
  v_dot2c_f32_bf16 v20, v16, v22
  v_dot2c_f32_bf16 v21, v16, v16
  v_dot2c_f32_bf16 v20, v17, v22
  v_dot2c_f32_bf16 v21, v17, v17
  s_nop 1
  v_add_f32_dpp v20, v20, v20 row_shr:1 row_mask:0xf bank_mask:0xf bound_ctrl:0
  v_add_f32_dpp v21, v21, v21 row_shr:1 row_mask:0xf bank_mask:0xf bound_ctrl:0
  s_nop 0
  v_add_f32_dpp v20, v20, v20 row_shr:2 row_mask:0xf bank_mask:0xf bound_ctrl:0
  v_add_f32_dpp v21, v21, v21 row_shr:2 row_mask:0xf bank_mask:0xf bound_ctrl:0
  s_nop 0
  v_add_f32_dpp v20, v20, v20 row_shr:4 row_mask:0xf bank_mask:0xf bound_ctrl:0
  v_add_f32_dpp v21, v21, v21 row_shr:4 row_mask:0xf bank_mask:0xf bound_ctrl:0
  s_nop 0
  v_add_f32_dpp v20, v20, v20 row_shr:8 row_mask:0xf bank_mask:0xf bound_ctrl:0
  v_add_f32_dpp v21, v21, v21 row_shr:8 row_mask:0xf bank_mask:0xf bound_ctrl:0
  s_nop 0
  v_add_f32_dpp v20, v20, v20 row_bcast:15 row_mask:0xa bank_mask:0xf
  v_add_f32_dpp v21, v21, v21 row_bcast:15 row_mask:0xa bank_mask:0xf
  s_nop 0
  v_add_f32_dpp v20, v20, v20 row_bcast:31 row_mask:0xc bank_mask:0xf
  v_add_f32_dpp v21, v21, v21 row_bcast:31 row_mask:0xc bank_mask:0xf
  v_readlane_b32 s10, v20, 63
  v_readlane_b32 s11, v21, 63
  v_mov_b32 v21, 0x3acccccd
  v_mul_f32 v20, s10, v21
  v_mul_f32 v21, s11, v21
  v_fma_f32 v21, -v20, v20, v21
  v_max_f32 v21, 0, v21
  v_add_f32 v22, 0x3727c5ac, v21
  v_rsq_f32 v22, v22
  v_sub_f32 v18, 0, v20
  v_sub_f32 v19, 0, v20
  v_mul_f32 v23, v22, v22
  v_mov_b32 v6, 0x3727c5ac
  v_fma_f32 v23, v23, v21, v6
  v_rsq_f32 v23, v23
  v_pk_add_f32 v[24:25], v[24:25], v[18:19]
  v_pk_add_f32 v[26:27], v[26:27], v[18:19]
  v_mul_f32 v22, v22, v23
  v_pk_mul_f32 v[24:25], v[24:25], v[22:23] op_sel_hi:[1,0]
  v_pk_mul_f32 v[26:27], v[26:27], v[22:23] op_sel_hi:[1,0]
  v_mov_b32 v23, 0
  s_mov_b64 exec, 1
  ds_write_b128 v23, v[24:27] offset:9216
  s_mov_b64 exec, -1
  s_cmp_eq_u32 s2, 0
  s_cbranch_scc0 L_mlp
  v_mov_b32 v6, s79
  s_mov_b64 exec, 1
  buffer_store_dword v6, off, s[52:55], 0 sc1
  s_mov_b64 exec, -1
L_mlp:
  s_waitcnt lgkmcnt(0)
  s_barrier
  ds_read_b32 v8, v4 offset:9216
  ds_read_b32 v10, v4 offset:9232
  s_mov_b32 s13, 1
  s_waitcnt lgkmcnt(0)
L_mlp_body:
  v_pk_fma_f32 v[16:17], v[8:9], v[64:65], v[88:89] op_sel_hi:[0,1,1]
  v_pk_fma_f32 v[18:19], v[8:9], v[66:67], v[90:91] op_sel_hi:[0,1,1]
  v_pk_fma_f32 v[20:21], v[8:9], v[68:69], v[92:93] op_sel_hi:[0,1,1]
  v_pk_fma_f32 v[22:23], v[8:9], v[70:71], v[94:95] op_sel_hi:[0,1,1]
  v_pk_fma_f32 v[24:25], v[8:9], v[72:73], v[96:97] op_sel_hi:[0,1,1]
  v_pk_fma_f32 v[26:27], v[8:9], v[74:75], v[98:99] op_sel_hi:[0,1,1]
  v_pk_fma_f32 v[28:29], v[8:9], v[76:77], v[100:101] op_sel_hi:[0,1,1]
  v_pk_fma_f32 v[30:31], v[8:9], v[78:79], v[102:103] op_sel_hi:[0,1,1]
  v_pk_fma_f32 v[32:33], v[8:9], v[80:81], v[104:105] op_sel_hi:[0,1,1]
  v_pk_fma_f32 v[34:35], v[8:9], v[82:83], v[106:107] op_sel_hi:[0,1,1]
  v_pk_fma_f32 v[36:37], v[8:9], v[84:85], v[108:109] op_sel_hi:[0,1,1]
  v_pk_fma_f32 v[38:39], v[8:9], v[86:87], v[110:111] op_sel_hi:[0,1,1]
  v_pk_mul_f32 v[160:161], v[16:17], v[16:17]
  v_pk_mul_f32 v[162:163], v[18:19], v[18:19]
  v_pk_mul_f32 v[164:165], v[20:21], v[20:21]
  v_pk_mul_f32 v[166:167], v[22:23], v[22:23]
  v_pk_mul_f32 v[168:169], v[24:25], v[24:25]
  v_pk_mul_f32 v[170:171], v[26:27], v[26:27]
  v_pk_mul_f32 v[172:173], v[28:29], v[28:29]
  v_pk_mul_f32 v[174:175], v[30:31], v[30:31]
  v_pk_mul_f32 v[176:177], v[32:33], v[32:33]
  v_pk_mul_f32 v[178:179], v[34:35], v[34:35]
  v_pk_mul_f32 v[180:181], v[36:37], v[36:37]
  v_pk_mul_f32 v[182:183], v[38:39], v[38:39]
  v_pk_fma_f32 v[160:161], v[160:161], s[70:71], v[62:63]
  v_pk_fma_f32 v[162:163], v[162:163], s[70:71], v[62:63]
  v_pk_fma_f32 v[164:165], v[164:165], s[70:71], v[62:63]
  v_pk_fma_f32 v[166:167], v[166:167], s[70:71], v[62:63]
  v_pk_fma_f32 v[168:169], v[168:169], s[70:71], v[62:63]
  v_pk_fma_f32 v[170:171], v[170:171], s[70:71], v[62:63]
  v_pk_fma_f32 v[172:173], v[172:173], s[70:71], v[62:63]
  v_pk_fma_f32 v[174:175], v[174:175], s[70:71], v[62:63]
  v_pk_fma_f32 v[176:177], v[176:177], s[70:71], v[62:63]
  v_pk_fma_f32 v[178:179], v[178:179], s[70:71], v[62:63]
  v_pk_fma_f32 v[180:181], v[180:181], s[70:71], v[62:63]
  v_pk_fma_f32 v[182:183], v[182:183], s[70:71], v[62:63]
  v_pk_mul_f32 v[160:161], v[160:161], v[16:17]
  v_pk_mul_f32 v[162:163], v[162:163], v[18:19]
  v_pk_mul_f32 v[164:165], v[164:165], v[20:21]
  v_pk_mul_f32 v[166:167], v[166:167], v[22:23]
  v_pk_mul_f32 v[168:169], v[168:169], v[24:25]
  v_pk_mul_f32 v[170:171], v[170:171], v[26:27]
  v_pk_mul_f32 v[172:173], v[172:173], v[28:29]
  v_pk_mul_f32 v[174:175], v[174:175], v[30:31]
  v_pk_mul_f32 v[176:177], v[176:177], v[32:33]
  v_pk_mul_f32 v[178:179], v[178:179], v[34:35]
  v_pk_mul_f32 v[180:181], v[180:181], v[36:37]
  v_pk_mul_f32 v[182:183], v[182:183], v[38:39]
  v_exp_f32 v160, v160
  v_exp_f32 v161, v161
  v_exp_f32 v162, v162
  v_exp_f32 v163, v163
  v_exp_f32 v164, v164
  v_exp_f32 v165, v165
  v_exp_f32 v166, v166
  v_exp_f32 v167, v167
  v_exp_f32 v168, v168
  v_exp_f32 v169, v169
  v_exp_f32 v170, v170
  v_exp_f32 v171, v171
  v_exp_f32 v172, v172
  v_exp_f32 v173, v173
  v_exp_f32 v174, v174
  v_exp_f32 v175, v175
  v_exp_f32 v176, v176
  v_exp_f32 v177, v177
  v_exp_f32 v178, v178
  v_exp_f32 v179, v179
  v_exp_f32 v180, v180
  v_exp_f32 v181, v181
  v_exp_f32 v182, v182
  v_exp_f32 v183, v183
  v_pk_add_f32 v[160:161], v[160:161], 1.0 op_sel_hi:[1,0]
  v_pk_add_f32 v[162:163], v[162:163], 1.0 op_sel_hi:[1,0]
  v_pk_add_f32 v[164:165], v[164:165], 1.0 op_sel_hi:[1,0]
  v_pk_add_f32 v[166:167], v[166:167], 1.0 op_sel_hi:[1,0]
  v_pk_add_f32 v[168:169], v[168:169], 1.0 op_sel_hi:[1,0]
  v_pk_add_f32 v[170:171], v[170:171], 1.0 op_sel_hi:[1,0]
  v_pk_add_f32 v[172:173], v[172:173], 1.0 op_sel_hi:[1,0]
  v_pk_add_f32 v[174:175], v[174:175], 1.0 op_sel_hi:[1,0]
  v_pk_add_f32 v[176:177], v[176:177], 1.0 op_sel_hi:[1,0]
  v_pk_add_f32 v[178:179], v[178:179], 1.0 op_sel_hi:[1,0]
  v_pk_add_f32 v[180:181], v[180:181], 1.0 op_sel_hi:[1,0]
  v_pk_add_f32 v[182:183], v[182:183], 1.0 op_sel_hi:[1,0]
  v_rcp_f32 v160, v160
  v_rcp_f32 v161, v161
  v_rcp_f32 v162, v162
  v_rcp_f32 v163, v163
  v_rcp_f32 v164, v164
  v_rcp_f32 v165, v165
  v_rcp_f32 v166, v166
  v_rcp_f32 v167, v167
  v_rcp_f32 v168, v168
  v_rcp_f32 v169, v169
  v_rcp_f32 v170, v170
  v_rcp_f32 v171, v171
  v_rcp_f32 v172, v172
  v_rcp_f32 v173, v173
  v_rcp_f32 v174, v174
  v_rcp_f32 v175, v175
  v_rcp_f32 v176, v176
  v_rcp_f32 v177, v177
  v_rcp_f32 v178, v178
  v_rcp_f32 v179, v179
  v_rcp_f32 v180, v180
  v_rcp_f32 v181, v181
  v_rcp_f32 v182, v182
  v_rcp_f32 v183, v183
  v_pk_mul_f32 v[16:17], v[16:17], v[160:161]
  v_pk_mul_f32 v[18:19], v[18:19], v[162:163]
  v_pk_mul_f32 v[20:21], v[20:21], v[164:165]
  v_pk_mul_f32 v[22:23], v[22:23], v[166:167]
  v_pk_mul_f32 v[24:25], v[24:25], v[168:169]
  v_pk_mul_f32 v[26:27], v[26:27], v[170:171]
  v_pk_mul_f32 v[28:29], v[28:29], v[172:173]
  v_pk_mul_f32 v[30:31], v[30:31], v[174:175]
  v_pk_mul_f32 v[32:33], v[32:33], v[176:177]
  v_pk_mul_f32 v[34:35], v[34:35], v[178:179]
  v_pk_mul_f32 v[36:37], v[36:37], v[180:181]
  v_pk_mul_f32 v[38:39], v[38:39], v[182:183]
  v_mov_b32 v60, 0
  v_mov_b32 v61, 0
  v_mov_b32 v58, 0
  v_mov_b32 v59, 0
  v_pk_fma_f32 v[58:59], v[16:17], v[112:113], v[58:59]
  v_pk_fma_f32 v[60:61], v[18:19], v[114:115], v[60:61]
  v_pk_fma_f32 v[58:59], v[20:21], v[116:117], v[58:59]
  v_pk_fma_f32 v[60:61], v[22:23], v[118:119], v[60:61]
  v_pk_fma_f32 v[58:59], v[24:25], v[120:121], v[58:59]
  v_pk_fma_f32 v[60:61], v[26:27], v[122:123], v[60:61]
  v_pk_fma_f32 v[58:59], v[28:29], v[124:125], v[58:59]
  v_pk_fma_f32 v[60:61], v[30:31], v[126:127], v[60:61]
  v_pk_fma_f32 v[58:59], v[32:33], v[128:129], v[58:59]
  v_pk_fma_f32 v[60:61], v[34:35], v[130:131], v[60:61]
  v_pk_fma_f32 v[58:59], v[36:37], v[132:133], v[58:59]
  v_pk_fma_f32 v[60:61], v[38:39], v[134:135], v[60:61]
  v_pk_add_f32 v[58:59], v[58:59], v[60:61]
  v_add_f32 v58, v58, v59
  s_nop 1
  v_add_f32_dpp v58, v58, v58 row_shr:1 row_mask:0xf bank_mask:0xf bound_ctrl:0
  s_nop 1
  v_add_f32_dpp v58, v58, v58 row_shr:2 row_mask:0xf bank_mask:0xf bound_ctrl:0
  s_nop 1
  v_add_f32_dpp v58, v58, v58 row_shr:4 row_mask:0xf bank_mask:0xf bound_ctrl:0
  s_nop 1
  v_add_f32_dpp v58, v58, v58 row_shr:8 row_mask:0xf bank_mask:0xf bound_ctrl:0
  s_nop 1
  v_add_f32_dpp v58, v58, v58 row_bcast:15 row_mask:0xa bank_mask:0xf
  s_nop 1
  v_add_f32_dpp v58, v58, v58 row_bcast:31 row_mask:0xc bank_mask:0xf
  v_cvt_pk_bf16_f32 v58, v58, v58
  v_and_b32 v58, 0xffff0000, v58
  v_add_f32 v58, v57, v58
  v_cvt_pk_bf16_f32 v58, v58, v58
  v_and_b32 v58, 0xffff0000, v58
  v_add_f32 v58, v58, v10
  v_cvt_pk_bf16_f32 v58, v58, v58
  s_mov_b32 exec_lo, 0
  s_mov_b32 exec_hi, 0x80000000
  buffer_store_short v58, off, s[64:67], s14
  s_branch L_done
L_prep123:
  s_mov_b32 s64, s34
  s_mov_b32 s65, s35
  s_mov_b32 s66, 2
  s_mov_b32 s67, 0x20000
  buffer_load_ushort v57, off, s[64:67], 0
  v_lshlrev_b32 v56, 4, v0
  ds_read_b128 v[160:163], v56 offset:9472
  ds_read_b128 v[164:167], v56 offset:10496
  ds_read_b128 v[168:171], v56 offset:11520
  ds_read_b128 v[172:175], v56 offset:12544
  ds_read_b128 v[176:179], v56 offset:13568
  ds_read_b128 v[180:183], v56 offset:14592
  ds_read_b128 v[184:187], v56 offset:15616
  ds_read_b128 v[188:191], v56 offset:16640
  ds_read_b128 v[192:195], v56 offset:17664
  s_mov_b32 s70, 0xbdd2d3e8
  s_mov_b32 s71, 0xbdd2d3e8
  v_mov_b32 v62, 0xc0135761
  v_mov_b32 v63, 0xc0135761
  s_lshl_b32 s8, s3, 2
  v_mov_b32 v4, s8
  s_and_b32 s8, s3, 1
  s_lshl_b32 s8, s8, 1
  s_lshr_b32 s9, s3, 1
  s_lshl_b32 s9, s9, 4
  s_add_u32 s8, s8, s9
  s_add_u32 s14, s8, s68
  s_mov_b32 s64, s36
  s_mov_b32 s65, s37
  s_mov_b32 s66, 1280
  s_mov_b32 s67, 0x20000
  v_mov_b32 v58, 0
  v_mov_b32 v59, 0
  s_waitcnt lgkmcnt(6)
  v_lshlrev_b32 v64, 16, v160
  v_and_b32 v65, 0xffff0000, v160
  v_lshlrev_b32 v66, 16, v161
  v_and_b32 v67, 0xffff0000, v161
  v_lshlrev_b32 v68, 16, v162
  v_and_b32 v69, 0xffff0000, v162
  v_lshlrev_b32 v70, 16, v163
  v_and_b32 v71, 0xffff0000, v163
  v_lshlrev_b32 v72, 16, v164
  v_and_b32 v73, 0xffff0000, v164
  v_lshlrev_b32 v74, 16, v165
  v_and_b32 v75, 0xffff0000, v165
  v_lshlrev_b32 v76, 16, v166
  v_and_b32 v77, 0xffff0000, v166
  v_lshlrev_b32 v78, 16, v167
  v_and_b32 v79, 0xffff0000, v167
  v_lshlrev_b32 v80, 16, v168
  v_and_b32 v81, 0xffff0000, v168
  v_lshlrev_b32 v82, 16, v169
  v_and_b32 v83, 0xffff0000, v169
  v_lshlrev_b32 v84, 16, v170
  v_and_b32 v85, 0xffff0000, v170
  v_lshlrev_b32 v86, 16, v171
  v_and_b32 v87, 0xffff0000, v171
  s_waitcnt lgkmcnt(3)
  v_lshlrev_b32 v88, 16, v172
  v_and_b32 v89, 0xffff0000, v172
  v_lshlrev_b32 v90, 16, v173
  v_and_b32 v91, 0xffff0000, v173
  v_lshlrev_b32 v92, 16, v174
  v_and_b32 v93, 0xffff0000, v174
  v_lshlrev_b32 v94, 16, v175
  v_and_b32 v95, 0xffff0000, v175
  v_lshlrev_b32 v96, 16, v176
  v_and_b32 v97, 0xffff0000, v176
  v_lshlrev_b32 v98, 16, v177
  v_and_b32 v99, 0xffff0000, v177
  v_lshlrev_b32 v100, 16, v178
  v_and_b32 v101, 0xffff0000, v178
  v_lshlrev_b32 v102, 16, v179
  v_and_b32 v103, 0xffff0000, v179
  v_lshlrev_b32 v104, 16, v180
  v_and_b32 v105, 0xffff0000, v180
  v_lshlrev_b32 v106, 16, v181
  v_and_b32 v107, 0xffff0000, v181
  v_lshlrev_b32 v108, 16, v182
  v_and_b32 v109, 0xffff0000, v182
  v_lshlrev_b32 v110, 16, v183
  v_and_b32 v111, 0xffff0000, v183
  s_waitcnt lgkmcnt(0)
  v_lshlrev_b32 v112, 16, v184
  v_and_b32 v113, 0xffff0000, v184
  v_lshlrev_b32 v114, 16, v185
  v_and_b32 v115, 0xffff0000, v185
  v_lshlrev_b32 v116, 16, v186
  v_and_b32 v117, 0xffff0000, v186
  v_lshlrev_b32 v118, 16, v187
  v_and_b32 v119, 0xffff0000, v187
  v_lshlrev_b32 v120, 16, v188
  v_and_b32 v121, 0xffff0000, v188
  v_lshlrev_b32 v122, 16, v189
  v_and_b32 v123, 0xffff0000, v189
  v_lshlrev_b32 v124, 16, v190
  v_and_b32 v125, 0xffff0000, v190
  v_lshlrev_b32 v126, 16, v191
  v_and_b32 v127, 0xffff0000, v191
  v_lshlrev_b32 v128, 16, v192
  v_and_b32 v129, 0xffff0000, v192
  v_lshlrev_b32 v130, 16, v193
  v_and_b32 v131, 0xffff0000, v193
  v_lshlrev_b32 v132, 16, v194
  v_and_b32 v133, 0xffff0000, v194
  v_lshlrev_b32 v134, 16, v195
  v_and_b32 v135, 0xffff0000, v195
  s_waitcnt vmcnt(0) lgkmcnt(0)
  v_lshlrev_b32 v57, 16, v57
  s_branch L_mlp
L_done:
L_end:
  s_endpgm
.section .rodata,"a"
.p2align 6
.amdhsa_kernel sequential_preLN__sliding_block_cached__mixer_token_mlp__decode_kernel
  .amdhsa_next_free_vgpr 256
  .amdhsa_next_free_sgpr 102
  .amdhsa_accum_offset 256
  .amdhsa_group_segment_fixed_size 0
  .amdhsa_kernarg_size 104
  .amdhsa_user_sgpr_count 2
  .amdhsa_user_sgpr_kernarg_segment_ptr 1
  .amdhsa_system_sgpr_workgroup_id_x 1
  .amdhsa_float_denorm_mode_32 3
.end_amdhsa_kernel
```
